```python
import torch

def _softmax(x, axis=-1):
    return torch.softmax(x, dim=axis)
def _gelu(x):
    return torch.nn.functional.gelu(x, approximate="tanh")
def _silu(x):
    return torch.nn.functional.silu(x)
def _sigmoid(x):
    return torch.sigmoid(x)
def _layernorm(x, axis=-1, eps=1e-5):
    m = x.mean(dim=axis, keepdim=True)
    v = x.var(dim=axis, keepdim=True, unbiased=False)
    return (x - m) / torch.sqrt(v + eps)
def _scatter_add(tgt, idx, src, axis=0):
    return tgt.clone().index_add_(axis, idx, src)
def _segment_sum(src, seg, n):
    out = torch.zeros((n,) + src.shape[1:], dtype=src.dtype)
    return out.index_add_(0, seg, src)
def _pad(x, pw):
    flat = tuple(v for pair in reversed(pw) for v in pair)
    return torch.nn.functional.pad(x, flat)

kernel_name = 'standalone__weight_only_int_quip_2__prompt'

def setup_inputs():

    _w = (lambda a: (lambda t: t.to(torch.bfloat16) if t.is_floating_point() else t)(torch.as_tensor(a)))
    B, S, D, F = 1, 2048, 576, 4608
    nbits = max(2, min(4, int(2)))
    G = -1 if -1 > 0 else D
    D = (D // G) * G
    ng = D // G
    qmax = 1 << nbits
    qw = torch.randint(0, qmax, (D, F)).to(torch.int32)
    zp = torch.randint(0, qmax, (ng, F)).to(float)
    sc = torch.abs((lambda *s: torch.randn(*s, dtype=torch.bfloat16) * 0.05)(ng, F)).to(float) * 0.1 + 0.02
    return {
        "x": _w((lambda *s: torch.randn(*s, dtype=torch.bfloat16) * 0.05)(B, S, D)),
        "qw": _w(qw),
        "scales": _w(sc),
        "zeros": _w(zp),
    }

def reference(x, qw, scales, zeros):
    B, S, D = x.shape
    ng, F = scales.shape
    G = D // ng
    s = (lambda x, n, axis: torch.repeat_interleave(x, n, dim=axis))(scales, G, axis=0)
    z = (lambda x, n, axis: torch.repeat_interleave(x, n, dim=axis))(zeros, G, axis=0)
    w = ((lambda x, dt: x.to(dt))(qw, x.dtype) - z) * s
    return torch.einsum("bsd,df->bsf", x, w)
```

```asm
; @launch grid=(256,1,1) block=(256,1,1) lds=147456
.amdgcn_target "amdgcn-amd-amdhsa--gfx950"
.text
.globl standalone__weight_only_int_quip_2__prompt_kernel
.p2align 8
.type standalone__weight_only_int_quip_2__prompt_kernel,@function
standalone__weight_only_int_quip_2__prompt_kernel:
    s_cmp_ge_u32 s2, 256
    s_cbranch_scc1 K_done
    s_load_dwordx2 s[24:25], s[0:1], 8
    s_load_dwordx2 s[20:21], s[0:1], 0
    s_load_dwordx2 s[32:33], s[0:1], 24
    s_load_dwordx2 s[40:41], s[0:1], 48
    s_load_dwordx2 s[28:29], s[0:1], 16
    s_load_dwordx2 s[36:37], s[0:1], 32
    v_lshrrev_b32 v176, 6, v0
    v_and_b32 v250, 63, v0
    v_readfirstlane_b32 s48, v176
    s_mov_b32 s26, 10616832
    s_mov_b32 s27, 0x00020000
    s_mov_b32 s22, 2359296
    s_mov_b32 s23, 0x00020000
    s_mov_b32 s34, 9216
    s_mov_b32 s35, 0x00020000
    s_mov_b32 s42, 268435456
    s_mov_b32 s43, 0x00020000
    s_mov_b32 s30, 9216
    s_mov_b32 s31, 0x00020000
    s_mov_b32 s38, 18874368
    s_mov_b32 s39, 0x00020000
    s_and_b32 s51, s2, 7
    s_lshr_b32 s52, s2, 3
    s_lshl_b32 s49, s51, 2
    s_and_b32 s92, s52, 3
    s_add_u32 s49, s49, s92
    s_lshr_b32 s50, s52, 2
    v_and_b32 v245, 15, v250
    v_lshrrev_b32 v253, 4, v250
    s_lshl_b32 s94, s50, 8
    s_mov_b32 s18, 0
    s_mov_b32 s19, 0
    s_mov_b32 s15, 0
    s_mov_b32 s72, 0
    s_cmp_eq_u32 s48, 3
    s_cbranch_scc1 K_p0w3
    s_lshl_b32 s52, s48, 5
    s_add_u32 s52, s52, s49
    s_mul_i32 s92, s52, 171
    s_lshr_b32 s92, s92, 12
    s_mul_i32 s93, s92, 24
    s_sub_u32 s52, s52, s93
    s_lshr_b32 s74, s52, 2
    s_and_b32 s52, s52, 3
    s_lshr_b32 s73, s92, 1
    s_lshl_b32 s73, s73, 3
    s_and_b32 s92, s92, 1
    s_add_u32 s73, s73, s92
    v_lshlrev_b32 v176, 8, v253
    v_lshl_add_u32 v152, v245, 3, v176
    v_add_u32 v156, 18432, v152
    v_add_u32 v157, 36864, v152
    v_add_u32 v158, 55296, v152
    v_add_u32 v159, 73728, v152
    v_add_u32 v160, 92160, v152
    v_add_u32 v161, 110592, v152
    v_add_u32 v162, 129024, v152
    s_mul_i32 s92, s74, 96
    s_lshl_b32 s93, s52, 3
    s_add_u32 s92, s92, s93
    s_mul_i32 s69, s92, 18432
    s_mul_i32 s92, s50, 576
    s_lshl_b32 s93, s73, 5
    s_add_u32 s92, s92, s93
    s_lshl_b32 s71, s92, 1
    s_lshl_b32 s92, s92, 2
    s_add_u32 s69, s69, s92
    v_lshrrev_b32 v153, 1, v152
    v_mul_u32_u24 v154, 24576, v253
    v_lshl_add_u32 v154, v245, 4, v154
    v_add_u32 v155, 1024, v154
    s_mul_i32 s92, s50, 18
    s_add_u32 s92, s92, s73
    s_mul_i32 s92, s92, 12
    s_lshl_b32 s93, s74, 1
    s_add_u32 s92, s92, s93
    s_lshl_b32 s70, s92, 10
    s_lshl_b32 s52, s52, 8
    s_add_u32 s70, s70, s52
    s_add_u32 s70, s70, 4096
    s_mov_b32 s72, 1
    s_branch K_p0end
K_p0w3:
    s_and_b32 s92, s50, 1
    s_lshl_b32 s92, s92, 2
    s_add_u32 s92, s92, s49
    s_and_b32 s93, s92, 7
    s_bfe_u32 s92, s92, 0x20003
    s_mul_i32 s92, s92, 3
    s_add_u32 s19, s92, s93
    s_add_u32 s19, s19, 1
    s_cmp_lt_u32 s93, 3
    s_cselect_b32 s72, 1, 0
    s_cselect_b32 s19, s19, 1
    s_sub_u32 s52, s19, 1
    s_lshr_b32 s74, s52, 1
    s_and_b32 s52, s52, 1
    v_and_b32 v176, 31, v250
    v_lshrrev_b32 v177, 5, v250
    v_mul_u32_u24 v178, 147456, v177
    v_lshl_add_u32 v152, v176, 3, v178
    v_add_u32 v156, 18432, v152
    v_add_u32 v157, 36864, v152
    v_add_u32 v158, 55296, v152
    v_add_u32 v159, 73728, v152
    v_add_u32 v160, 92160, v152
    v_add_u32 v161, 110592, v152
    v_add_u32 v162, 129024, v152
    s_mul_i32 s92, s74, 96
    s_lshl_b32 s93, s52, 4
    s_add_u32 s92, s92, s93
    s_mul_i32 s69, s92, 18432
    s_mul_i32 s92, s50, 576
    s_add_u32 s92, s92, 512
    s_lshl_b32 s71, s92, 1
    s_lshl_b32 s92, s92, 2
    s_add_u32 s69, s69, s92
    v_lshlrev_b32 v153, 2, v176
    v_lshrrev_b32 v178, 3, v176
    v_mul_u32_u24 v178, 6144, v178
    v_lshl_add_u32 v178, v177, 8, v178
    v_and_b32 v176, 7, v176
    v_lshl_add_u32 v154, v176, 5, v178
    v_add_u32 v155, 16, v154
    s_mul_i32 s92, s50, 18
    s_add_u32 s92, s92, 16
    s_mul_i32 s70, s92, 12288
    s_lshl_b32 s93, s74, 10
    s_add_u32 s70, s70, s93
    s_lshl_b32 s52, s52, 9
    s_add_u32 s70, s70, s52
    s_add_u32 s70, s70, 4096
K_p0end:
    s_waitcnt lgkmcnt(0)
    s_load_dword s54, s[40:41], s94
    s_cmp_ge_u32 s48, 1
    s_cbranch_scc1 K_late
    buffer_load_dword v132, v153, s[32:35], s71 offen
    buffer_load_dwordx2 v[84:85], v152, s[24:27], s69 offen nt
    buffer_load_dwordx2 v[86:87], v156, s[24:27], s69 offen nt
    buffer_load_dwordx2 v[88:89], v157, s[24:27], s69 offen nt
    buffer_load_dwordx2 v[90:91], v158, s[24:27], s69 offen nt
    buffer_load_dwordx2 v[92:93], v159, s[24:27], s69 offen nt
    buffer_load_dwordx2 v[94:95], v160, s[24:27], s69 offen nt
    buffer_load_dwordx2 v[96:97], v161, s[24:27], s69 offen nt
    buffer_load_dwordx2 v[98:99], v162, s[24:27], s69 offen nt
    s_add_u32 s69, s69, 589824
    buffer_load_dwordx2 v[100:101], v152, s[24:27], s69 offen nt
    buffer_load_dwordx2 v[102:103], v156, s[24:27], s69 offen nt
    buffer_load_dwordx2 v[104:105], v157, s[24:27], s69 offen nt
    buffer_load_dwordx2 v[106:107], v158, s[24:27], s69 offen nt
    buffer_load_dwordx2 v[108:109], v159, s[24:27], s69 offen nt
    buffer_load_dwordx2 v[110:111], v160, s[24:27], s69 offen nt
    buffer_load_dwordx2 v[112:113], v161, s[24:27], s69 offen nt
    buffer_load_dwordx2 v[114:115], v162, s[24:27], s69 offen nt
    s_add_u32 s69, s69, 589824
    buffer_load_dwordx2 v[116:117], v152, s[24:27], s69 offen nt
    buffer_load_dwordx2 v[118:119], v156, s[24:27], s69 offen nt
    buffer_load_dwordx2 v[120:121], v157, s[24:27], s69 offen nt
    buffer_load_dwordx2 v[122:123], v158, s[24:27], s69 offen nt
    buffer_load_dwordx2 v[124:125], v159, s[24:27], s69 offen nt
    buffer_load_dwordx2 v[126:127], v160, s[24:27], s69 offen nt
    buffer_load_dwordx2 v[128:129], v161, s[24:27], s69 offen nt
    buffer_load_dwordx2 v[130:131], v162, s[24:27], s69 offen nt
    s_and_b32 s92, s50, 1
    s_lshl_b32 s92, s92, 2
    v_xor_b32 v178, s92, v250
    v_add_u32 v176, 0, v178
    v_mul_u32_u24 v177, 911, v176
    v_lshrrev_b32 v177, 17, v177
    v_xor_b32 v176, v176, v177
    v_lshlrev_b32 v164, 4, v176
    v_add_u32 v176, 64, v178
    v_mul_u32_u24 v177, 911, v176
    v_lshrrev_b32 v177, 17, v177
    v_xor_b32 v176, v176, v177
    v_lshlrev_b32 v165, 4, v176
    v_add_u32 v176, 128, v178
    v_mul_u32_u24 v177, 911, v176
    v_lshrrev_b32 v177, 17, v177
    v_xor_b32 v176, v176, v177
    v_lshlrev_b32 v166, 4, v176
    v_add_u32 v176, 192, v178
    v_mul_u32_u24 v177, 911, v176
    v_lshrrev_b32 v177, 17, v177
    v_xor_b32 v176, v176, v177
    v_lshlrev_b32 v167, 4, v176
    v_add_u32 v176, 256, v178
    v_mul_u32_u24 v177, 911, v176
    v_lshrrev_b32 v177, 17, v177
    v_xor_b32 v176, v176, v177
    v_lshlrev_b32 v168, 4, v176
    v_add_u32 v176, 320, v178
    v_mul_u32_u24 v177, 911, v176
    v_lshrrev_b32 v177, 17, v177
    v_xor_b32 v176, v176, v177
    v_lshlrev_b32 v169, 4, v176
    v_add_u32 v176, 384, v178
    v_mul_u32_u24 v177, 911, v176
    v_lshrrev_b32 v177, 17, v177
    v_xor_b32 v176, v176, v177
    v_lshlrev_b32 v170, 4, v176
    v_add_u32 v176, 448, v178
    v_mul_u32_u24 v177, 911, v176
    v_lshrrev_b32 v177, 17, v177
    v_xor_b32 v176, v176, v177
    v_lshlrev_b32 v171, 4, v176
    v_add_u32 v176, 512, v178
    v_mul_u32_u24 v177, 911, v176
    v_lshrrev_b32 v177, 17, v177
    v_xor_b32 v176, v176, v177
    v_lshlrev_b32 v172, 4, v176
    v_lshlrev_b32 v244, 4, v250
    v_lshlrev_b32 v246, 4, v253
    v_lshlrev_b32 v242, 3, v253
    s_mul_i32 s51, s50, 18
    s_lshl_b32 s93, s48, 1
    s_add_u32 s52, s51, s93
    s_mul_i32 s62, s52, 12288
    s_add_u32 s62, s62, 4096
    s_add_u32 s52, s51, 16
    s_mul_i32 s52, s52, 12288
    s_add_u32 s52, s52, 4096
    s_mul_i32 s92, s48, 6144
    s_add_u32 s63, s52, s92
    s_min_u32 s92, s92, 12288
    s_add_u32 s61, s52, s92
    s_mul_i32 s52, s50, 1152
    s_lshl_b32 s93, s48, 7
    s_add_u32 s67, s52, s93
    s_lshl_b32 s92, s48, 5
    s_add_u32 s68, s52, s92
    s_add_u32 s68, s68, 1024
    s_mul_i32 s92, s49, 589824
    s_add_u32 s56, s52, s92
    s_add_u32 s57, s56, 147456
    s_add_u32 s58, s56, 294912
    s_add_u32 s59, s56, 442368
    s_mul_i32 s92, s48, 147456
    s_add_u32 s60, s56, s92
    s_add_u32 s60, s60, 1024
    s_sub_u32 s60, s60, s93
    s_mov_b32 s75, 2.0
    s_lshl_b32 s16, s48, 7
    s_lshl_b32 s52, s48, 14
    s_add_u32 s52, s52, 73728
    v_add_u32 v254, s52, v244
    v_and_b32 v176, 7, v245
    v_xor_b32 v177, v176, v253
    v_lshlrev_b32 v177, 4, v177
    v_lshl_add_u32 v177, v245, 7, v177
    v_add_u32 v251, s52, v177
    v_xor_b32 v252, 64, v251
    s_lshl_b32 s92, s48, 1
    v_lshrrev_b32 v177, 1, v253
    v_add_u32 v177, s92, v177
    v_xor_b32 v177, v177, v176
    v_lshlrev_b32 v177, 4, v177
    v_lshl_add_u32 v177, v245, 7, v177
    v_and_b32 v178, 1, v253
    v_lshl_add_u32 v177, v178, 3, v177
    v_add_u32 v243, 139264, v177
    v_lshrrev_b32 v176, 3, v250
    v_and_b32 v177, 7, v250
    v_xor_b32 v177, v177, v176
    v_mul_u32_u24 v176, 9216, v176
    v_lshl_add_u32 v176, v177, 4, v176
    v_add_u32 v247, s93, v176
    v_add_u32 v248, 73728, v247
    v_bfe_u32 v176, v245, 1, 3
    v_xor_b32 v176, v176, v253
    v_lshlrev_b32 v176, 4, v176
    v_mul_u32_u24 v177, 1152, v245
    v_add_u32 v240, v176, v177
    v_xor_b32 v241, 64, v240
    v_min_u32 v176, 47, v250
    v_lshrrev_b32 v177, 2, v176
    v_and_b32 v176, 3, v176
    v_lshlrev_b32 v176, 8, v176
    v_lshl_add_u32 v176, v177, 10, v176
    v_add_u32 v0, 12, v176
    s_lshl_b32 s52, s48, 14
    s_add_u32 s52, s52, 81920
    v_bfe_u32 v176, v245, 1, 2
    v_xor_b32 v176, v176, v253
    v_lshl_add_u32 v176, v245, 2, v176
    v_lshlrev_b32 v176, 4, v176
    v_add_u32 v245, s52, v176
    v_lshrrev_b32 v176, 2, v250
    v_mul_u32_u24 v176, 9216, v176
    v_bfe_u32 v177, v250, 3, 2
    v_and_b32 v178, 3, v250
    v_xor_b32 v177, v177, v178
    v_lshl_add_u32 v176, v177, 4, v176
    v_add_u32 v253, s16, v176
    s_lshl_b32 s92, s48, 6
    v_add_u32 v176, s92, v250
    v_cmp_eq_u32 vcc, 0, v176
    v_mov_b32 v177, s94
    v_mov_b32 v2, 2
    v_mov_b32 v1, 0x7ffffff0
    v_cndmask_b32 v1, v1, v177, vcc
    s_waitcnt lgkmcnt(0)
    s_mul_i32 s53, s54, 0x9e3779b1
    s_add_u32 s53, s53, 0x7f4a7c15
    s_waitcnt vmcnt(0)
    v_lshlrev_b32 v133, 16, v132
    v_and_b32 v134, 0xffff0000, v132
    v_cvt_u32_f32 v135, v133
    v_cvt_u32_f32 v136, v134
    v_cvt_f32_u32 v138, v135
    v_cvt_f32_u32 v139, v136
    v_or_b32 v137, v135, v136
    v_cmp_neq_f32 s[92:93], v138, v133
    v_cmp_neq_f32 vcc, v139, v134
    v_sub_u32 v135, 3, v135
    v_sub_u32 v136, 3, v136
    s_or_b64 s[92:93], s[92:93], vcc
    v_mov_b32 v138, 0x00090a0b
    s_mov_b32 s51, 0x00030201
    v_alignbyte_b32 v135, s51, v138, v135
    v_alignbyte_b32 v136, s51, v138, v136
    v_or3_b32 v137, v137, v84, v85
    v_or3_b32 v137, v137, v86, v87
    v_or3_b32 v137, v137, v88, v89
    v_or3_b32 v137, v137, v90, v91
    v_or3_b32 v137, v137, v92, v93
    v_or3_b32 v137, v137, v94, v95
    v_or3_b32 v137, v137, v96, v97
    v_or3_b32 v137, v137, v98, v99
    v_or3_b32 v137, v137, v100, v101
    v_or3_b32 v137, v137, v102, v103
    v_or3_b32 v137, v137, v104, v105
    v_or3_b32 v137, v137, v106, v107
    v_or3_b32 v137, v137, v108, v109
    v_or3_b32 v137, v137, v110, v111
    v_or3_b32 v137, v137, v112, v113
    v_or3_b32 v137, v137, v114, v115
    v_or3_b32 v137, v137, v116, v117
    v_or3_b32 v137, v137, v118, v119
    v_or3_b32 v137, v137, v120, v121
    v_or3_b32 v137, v137, v122, v123
    v_or3_b32 v137, v137, v124, v125
    v_or3_b32 v137, v137, v126, v127
    v_or3_b32 v137, v137, v128, v129
    v_or3_b32 v137, v137, v130, v131
    v_lshl_or_b32 v133, v96, 8, v92
    v_lshl_or_b32 v134, v98, 8, v94
    v_lshl_or_b32 v133, v133, 8, v88
    v_lshl_or_b32 v134, v134, 8, v90
    v_lshl_or_b32 v133, v133, 8, v84
    v_lshl_or_b32 v134, v134, 8, v86
    v_perm_b32 v133, v135, v135, v133
    v_perm_b32 v134, v135, v135, v134
    v_lshl_or_b32 v144, v134, 4, v133
    v_lshl_or_b32 v133, v97, 8, v93
    v_lshl_or_b32 v134, v99, 8, v95
    v_lshl_or_b32 v133, v133, 8, v89
    v_lshl_or_b32 v134, v134, 8, v91
    v_lshl_or_b32 v133, v133, 8, v85
    v_lshl_or_b32 v134, v134, 8, v87
    v_perm_b32 v133, v136, v136, v133
    v_perm_b32 v134, v136, v136, v134
    v_lshl_or_b32 v148, v134, 4, v133
    v_lshl_or_b32 v133, v112, 8, v108
    v_lshl_or_b32 v134, v114, 8, v110
    v_lshl_or_b32 v133, v133, 8, v104
    v_lshl_or_b32 v134, v134, 8, v106
    v_lshl_or_b32 v133, v133, 8, v100
    v_lshl_or_b32 v134, v134, 8, v102
    v_perm_b32 v133, v135, v135, v133
    v_perm_b32 v134, v135, v135, v134
    v_lshl_or_b32 v145, v134, 4, v133
    v_lshl_or_b32 v133, v113, 8, v109
    v_lshl_or_b32 v134, v115, 8, v111
    v_lshl_or_b32 v133, v133, 8, v105
    v_lshl_or_b32 v134, v134, 8, v107
    v_lshl_or_b32 v133, v133, 8, v101
    v_lshl_or_b32 v134, v134, 8, v103
    v_perm_b32 v133, v136, v136, v133
    v_perm_b32 v134, v136, v136, v134
    v_lshl_or_b32 v149, v134, 4, v133
    v_lshl_or_b32 v133, v128, 8, v124
    v_lshl_or_b32 v134, v130, 8, v126
    v_lshl_or_b32 v133, v133, 8, v120
    v_lshl_or_b32 v134, v134, 8, v122
    v_lshl_or_b32 v133, v133, 8, v116
    v_lshl_or_b32 v134, v134, 8, v118
    v_perm_b32 v133, v135, v135, v133
    v_perm_b32 v134, v135, v135, v134
    v_lshl_or_b32 v146, v134, 4, v133
    v_lshl_or_b32 v133, v129, 8, v125
    v_lshl_or_b32 v134, v131, 8, v127
    v_lshl_or_b32 v133, v133, 8, v121
    v_lshl_or_b32 v134, v134, 8, v123
    v_lshl_or_b32 v133, v133, 8, v117
    v_lshl_or_b32 v134, v134, 8, v119
    v_perm_b32 v133, v136, v136, v133
    v_perm_b32 v134, v136, v136, v134
    v_lshl_or_b32 v150, v134, 4, v133
    v_and_b32 v137, 0xfffffffc, v137
    v_cmp_ne_u32 vcc, 0, v137
    v_mov_b32 v147, s53
    v_mov_b32 v151, s53
    s_or_b64 s[92:93], s[92:93], vcc
    s_mov_b32 s72, 0
    s_cmp_lg_u64 s[92:93], 0
    s_cbranch_scc1 K_pubE
    s_mov_b32 s72, 1
    buffer_store_dwordx4 v[144:147], v154, s[40:43], s70 offen sc1
    buffer_store_dwordx4 v[148:151], v155, s[40:43], s70 offen sc1
K_pubE:
    s_getpc_b64 s[44:45]
K_pc420:
    s_mov_b32 s46, K_end-K_pc420
    s_mov_b32 s47, 0x00020000
    s_lshr_b32 s51, s2, 3
    s_lshl_b32 s51, s51, 10
    v_and_b32 v176, 7, v250
    v_lshlrev_b32 v176, 7, v176
    buffer_load_dword v255, v176, s[44:47], s51 offen
    s_mul_i32 s51, s50, 1152
    v_min_u32 v176, 8, v250
    v_lshlrev_b32 v176, 7, v176
    buffer_load_dword v255, v176, s[28:31], s51 offen
    s_mul_i32 s51, s49, 73728
    s_lshl_b32 s92, s48, 1
    s_add_u32 s92, s92, s50
    s_add_u32 s93, s92, 0
    s_and_b32 s93, s93, 7
    s_mul_i32 s95, s93, 9216
    s_add_u32 s64, s95, s51
    s_add_u32 m0, s95, 0
    s_nop 0
    buffer_load_dwordx4 v164, s[20:23], s64 offen lds
    s_add_u32 m0, s95, 1024
    s_nop 0
    buffer_load_dwordx4 v165, s[20:23], s64 offen lds
    s_add_u32 m0, s95, 2048
    s_nop 0
    buffer_load_dwordx4 v166, s[20:23], s64 offen lds
    s_add_u32 m0, s95, 3072
    s_nop 0
    buffer_load_dwordx4 v167, s[20:23], s64 offen lds
    s_add_u32 m0, s95, 4096
    s_nop 0
    buffer_load_dwordx4 v168, s[20:23], s64 offen lds
    s_add_u32 m0, s95, 5120
    s_nop 0
    buffer_load_dwordx4 v169, s[20:23], s64 offen lds
    s_add_u32 m0, s95, 6144
    s_nop 0
    buffer_load_dwordx4 v170, s[20:23], s64 offen lds
    s_add_u32 m0, s95, 7168
    s_nop 0
    buffer_load_dwordx4 v171, s[20:23], s64 offen lds
    s_add_u32 m0, s95, 8192
    s_nop 0
    buffer_load_dwordx4 v172, s[20:23], s64 offen lds
    v_xor_b32 v164, 64, v164
    v_xor_b32 v165, 64, v165
    v_xor_b32 v166, 64, v166
    v_xor_b32 v167, 64, v167
    v_xor_b32 v168, 64, v168
    v_xor_b32 v169, 64, v169
    v_xor_b32 v170, 64, v170
    v_xor_b32 v171, 64, v171
    v_xor_b32 v172, 64, v172
    s_add_u32 s93, s92, 1
    s_and_b32 s93, s93, 7
    s_mul_i32 s95, s93, 9216
    s_add_u32 s64, s95, s51
    s_add_u32 m0, s95, 0
    s_nop 0
    buffer_load_dwordx4 v164, s[20:23], s64 offen lds
    s_add_u32 m0, s95, 1024
    s_nop 0
    buffer_load_dwordx4 v165, s[20:23], s64 offen lds
    s_add_u32 m0, s95, 2048
    s_nop 0
    buffer_load_dwordx4 v166, s[20:23], s64 offen lds
    s_add_u32 m0, s95, 3072
    s_nop 0
    buffer_load_dwordx4 v167, s[20:23], s64 offen lds
    s_add_u32 m0, s95, 4096
    s_nop 0
    buffer_load_dwordx4 v168, s[20:23], s64 offen lds
    s_add_u32 m0, s95, 5120
    s_nop 0
    buffer_load_dwordx4 v169, s[20:23], s64 offen lds
    s_add_u32 m0, s95, 6144
    s_nop 0
    buffer_load_dwordx4 v170, s[20:23], s64 offen lds
    s_add_u32 m0, s95, 7168
    s_nop 0
    buffer_load_dwordx4 v171, s[20:23], s64 offen lds
    s_add_u32 m0, s95, 8192
    s_nop 0
    buffer_load_dwordx4 v172, s[20:23], s64 offen lds
    s_branch K_nopub
K_late:
    s_cmp_eq_u32 s48, 3
    s_cselect_b32 s15, s72, 0
    s_cselect_b32 s72, 0, s72
    s_cmp_eq_u32 s72, 0
    s_cbranch_scc1 K_nounit
    buffer_load_dword v132, v153, s[32:35], s71 offen
    buffer_load_dwordx2 v[84:85], v152, s[24:27], s69 offen nt
    buffer_load_dwordx2 v[86:87], v156, s[24:27], s69 offen nt
    buffer_load_dwordx2 v[88:89], v157, s[24:27], s69 offen nt
    buffer_load_dwordx2 v[90:91], v158, s[24:27], s69 offen nt
    buffer_load_dwordx2 v[92:93], v159, s[24:27], s69 offen nt
    buffer_load_dwordx2 v[94:95], v160, s[24:27], s69 offen nt
    buffer_load_dwordx2 v[96:97], v161, s[24:27], s69 offen nt
    buffer_load_dwordx2 v[98:99], v162, s[24:27], s69 offen nt
    s_add_u32 s69, s69, 589824
    buffer_load_dwordx2 v[100:101], v152, s[24:27], s69 offen nt
    buffer_load_dwordx2 v[102:103], v156, s[24:27], s69 offen nt
    buffer_load_dwordx2 v[104:105], v157, s[24:27], s69 offen nt
    buffer_load_dwordx2 v[106:107], v158, s[24:27], s69 offen nt
    buffer_load_dwordx2 v[108:109], v159, s[24:27], s69 offen nt
    buffer_load_dwordx2 v[110:111], v160, s[24:27], s69 offen nt
    buffer_load_dwordx2 v[112:113], v161, s[24:27], s69 offen nt
    buffer_load_dwordx2 v[114:115], v162, s[24:27], s69 offen nt
    s_add_u32 s69, s69, 589824
    buffer_load_dwordx2 v[116:117], v152, s[24:27], s69 offen nt
    buffer_load_dwordx2 v[118:119], v156, s[24:27], s69 offen nt
    buffer_load_dwordx2 v[120:121], v157, s[24:27], s69 offen nt
    buffer_load_dwordx2 v[122:123], v158, s[24:27], s69 offen nt
    buffer_load_dwordx2 v[124:125], v159, s[24:27], s69 offen nt
    buffer_load_dwordx2 v[126:127], v160, s[24:27], s69 offen nt
    buffer_load_dwordx2 v[128:129], v161, s[24:27], s69 offen nt
    buffer_load_dwordx2 v[130:131], v162, s[24:27], s69 offen nt
K_nounit:
    s_and_b32 s92, s50, 1
    s_lshl_b32 s92, s92, 2
    v_xor_b32 v178, s92, v250
    v_add_u32 v176, 0, v178
    v_mul_u32_u24 v177, 911, v176
    v_lshrrev_b32 v177, 17, v177
    v_xor_b32 v176, v176, v177
    v_lshlrev_b32 v164, 4, v176
    v_add_u32 v176, 64, v178
    v_mul_u32_u24 v177, 911, v176
    v_lshrrev_b32 v177, 17, v177
    v_xor_b32 v176, v176, v177
    v_lshlrev_b32 v165, 4, v176
    v_add_u32 v176, 128, v178
    v_mul_u32_u24 v177, 911, v176
    v_lshrrev_b32 v177, 17, v177
    v_xor_b32 v176, v176, v177
    v_lshlrev_b32 v166, 4, v176
    v_add_u32 v176, 192, v178
    v_mul_u32_u24 v177, 911, v176
    v_lshrrev_b32 v177, 17, v177
    v_xor_b32 v176, v176, v177
    v_lshlrev_b32 v167, 4, v176
    v_add_u32 v176, 256, v178
    v_mul_u32_u24 v177, 911, v176
    v_lshrrev_b32 v177, 17, v177
    v_xor_b32 v176, v176, v177
    v_lshlrev_b32 v168, 4, v176
    v_add_u32 v176, 320, v178
    v_mul_u32_u24 v177, 911, v176
    v_lshrrev_b32 v177, 17, v177
    v_xor_b32 v176, v176, v177
    v_lshlrev_b32 v169, 4, v176
    v_add_u32 v176, 384, v178
    v_mul_u32_u24 v177, 911, v176
    v_lshrrev_b32 v177, 17, v177
    v_xor_b32 v176, v176, v177
    v_lshlrev_b32 v170, 4, v176
    v_add_u32 v176, 448, v178
    v_mul_u32_u24 v177, 911, v176
    v_lshrrev_b32 v177, 17, v177
    v_xor_b32 v176, v176, v177
    v_lshlrev_b32 v171, 4, v176
    v_add_u32 v176, 512, v178
    v_mul_u32_u24 v177, 911, v176
    v_lshrrev_b32 v177, 17, v177
    v_xor_b32 v176, v176, v177
    v_lshlrev_b32 v172, 4, v176
    s_mul_i32 s51, s49, 73728
    s_lshl_b32 s92, s48, 1
    s_add_u32 s92, s92, s50
    s_add_u32 s93, s92, 0
    s_and_b32 s93, s93, 7
    s_mul_i32 s95, s93, 9216
    s_add_u32 s64, s95, s51
    s_add_u32 m0, s95, 0
    s_nop 0
    buffer_load_dwordx4 v164, s[20:23], s64 offen lds
    s_add_u32 m0, s95, 1024
    s_nop 0
    buffer_load_dwordx4 v165, s[20:23], s64 offen lds
    s_add_u32 m0, s95, 2048
    s_nop 0
    buffer_load_dwordx4 v166, s[20:23], s64 offen lds
    s_add_u32 m0, s95, 3072
    s_nop 0
    buffer_load_dwordx4 v167, s[20:23], s64 offen lds
    s_add_u32 m0, s95, 4096
    s_nop 0
    buffer_load_dwordx4 v168, s[20:23], s64 offen lds
    s_add_u32 m0, s95, 5120
    s_nop 0
    buffer_load_dwordx4 v169, s[20:23], s64 offen lds
    s_add_u32 m0, s95, 6144
    s_nop 0
    buffer_load_dwordx4 v170, s[20:23], s64 offen lds
    s_add_u32 m0, s95, 7168
    s_nop 0
    buffer_load_dwordx4 v171, s[20:23], s64 offen lds
    s_add_u32 m0, s95, 8192
    s_nop 0
    buffer_load_dwordx4 v172, s[20:23], s64 offen lds
    v_xor_b32 v164, 64, v164
    v_xor_b32 v165, 64, v165
    v_xor_b32 v166, 64, v166
    v_xor_b32 v167, 64, v167
    v_xor_b32 v168, 64, v168
    v_xor_b32 v169, 64, v169
    v_xor_b32 v170, 64, v170
    v_xor_b32 v171, 64, v171
    v_xor_b32 v172, 64, v172
    s_add_u32 s93, s92, 1
    s_and_b32 s93, s93, 7
    s_mul_i32 s95, s93, 9216
    s_add_u32 s64, s95, s51
    s_add_u32 m0, s95, 0
    s_nop 0
    buffer_load_dwordx4 v164, s[20:23], s64 offen lds
    s_add_u32 m0, s95, 1024
    s_nop 0
    buffer_load_dwordx4 v165, s[20:23], s64 offen lds
    s_add_u32 m0, s95, 2048
    s_nop 0
    buffer_load_dwordx4 v166, s[20:23], s64 offen lds
    s_add_u32 m0, s95, 3072
    s_nop 0
    buffer_load_dwordx4 v167, s[20:23], s64 offen lds
    s_add_u32 m0, s95, 4096
    s_nop 0
    buffer_load_dwordx4 v168, s[20:23], s64 offen lds
    s_add_u32 m0, s95, 5120
    s_nop 0
    buffer_load_dwordx4 v169, s[20:23], s64 offen lds
    s_add_u32 m0, s95, 6144
    s_nop 0
    buffer_load_dwordx4 v170, s[20:23], s64 offen lds
    s_add_u32 m0, s95, 7168
    s_nop 0
    buffer_load_dwordx4 v171, s[20:23], s64 offen lds
    s_add_u32 m0, s95, 8192
    s_nop 0
    buffer_load_dwordx4 v172, s[20:23], s64 offen lds
    v_lshlrev_b32 v244, 4, v250
    v_lshlrev_b32 v246, 4, v253
    v_lshlrev_b32 v242, 3, v253
    s_mul_i32 s51, s50, 18
    s_lshl_b32 s93, s48, 1
    s_add_u32 s52, s51, s93
    s_mul_i32 s62, s52, 12288
    s_add_u32 s62, s62, 4096
    s_add_u32 s52, s51, 16
    s_mul_i32 s52, s52, 12288
    s_add_u32 s52, s52, 4096
    s_mul_i32 s92, s48, 6144
    s_add_u32 s63, s52, s92
    s_min_u32 s92, s92, 12288
    s_add_u32 s61, s52, s92
    s_mul_i32 s52, s50, 1152
    s_lshl_b32 s93, s48, 7
    s_add_u32 s67, s52, s93
    s_lshl_b32 s92, s48, 5
    s_add_u32 s68, s52, s92
    s_add_u32 s68, s68, 1024
    s_mul_i32 s92, s49, 589824
    s_add_u32 s56, s52, s92
    s_add_u32 s57, s56, 147456
    s_add_u32 s58, s56, 294912
    s_add_u32 s59, s56, 442368
    s_mul_i32 s92, s48, 147456
    s_add_u32 s60, s56, s92
    s_add_u32 s60, s60, 1024
    s_sub_u32 s60, s60, s93
    s_mov_b32 s75, 2.0
    s_lshl_b32 s16, s48, 7
    s_lshl_b32 s52, s48, 14
    s_add_u32 s52, s52, 73728
    v_add_u32 v254, s52, v244
    v_and_b32 v176, 7, v245
    v_xor_b32 v177, v176, v253
    v_lshlrev_b32 v177, 4, v177
    v_lshl_add_u32 v177, v245, 7, v177
    v_add_u32 v251, s52, v177
    v_xor_b32 v252, 64, v251
    s_lshl_b32 s92, s48, 1
    v_lshrrev_b32 v177, 1, v253
    v_add_u32 v177, s92, v177
    v_xor_b32 v177, v177, v176
    v_lshlrev_b32 v177, 4, v177
    v_lshl_add_u32 v177, v245, 7, v177
    v_and_b32 v178, 1, v253
    v_lshl_add_u32 v177, v178, 3, v177
    v_add_u32 v243, 139264, v177
    v_lshrrev_b32 v176, 3, v250
    v_and_b32 v177, 7, v250
    v_xor_b32 v177, v177, v176
    v_mul_u32_u24 v176, 9216, v176
    v_lshl_add_u32 v176, v177, 4, v176
    v_add_u32 v247, s93, v176
    v_add_u32 v248, 73728, v247
    v_bfe_u32 v176, v245, 1, 3
    v_xor_b32 v176, v176, v253
    v_lshlrev_b32 v176, 4, v176
    v_mul_u32_u24 v177, 1152, v245
    v_add_u32 v240, v176, v177
    v_xor_b32 v241, 64, v240
    v_min_u32 v176, 47, v250
    v_lshrrev_b32 v177, 2, v176
    v_and_b32 v176, 3, v176
    v_lshlrev_b32 v176, 8, v176
    v_lshl_add_u32 v176, v177, 10, v176
    v_add_u32 v0, 12, v176
    s_lshl_b32 s52, s48, 14
    s_add_u32 s52, s52, 81920
    v_bfe_u32 v176, v245, 1, 2
    v_xor_b32 v176, v176, v253
    v_lshl_add_u32 v176, v245, 2, v176
    v_lshlrev_b32 v176, 4, v176
    v_add_u32 v245, s52, v176
    v_lshrrev_b32 v176, 2, v250
    v_mul_u32_u24 v176, 9216, v176
    v_bfe_u32 v177, v250, 3, 2
    v_and_b32 v178, 3, v250
    v_xor_b32 v177, v177, v178
    v_lshl_add_u32 v176, v177, 4, v176
    v_add_u32 v253, s16, v176
    s_lshl_b32 s92, s48, 6
    v_add_u32 v176, s92, v250
    v_cmp_eq_u32 vcc, 0, v176
    v_mov_b32 v177, s94
    v_mov_b32 v2, 2
    v_mov_b32 v1, 0x7ffffff0
    v_cndmask_b32 v1, v1, v177, vcc
    s_waitcnt lgkmcnt(0)
    s_mul_i32 s53, s54, 0x9e3779b1
    s_add_u32 s53, s53, 0x7f4a7c15
    s_cmp_eq_u32 s72, 0
    s_cbranch_scc1 K_nopub
    s_waitcnt vmcnt(18)
    v_lshlrev_b32 v133, 16, v132
    v_and_b32 v134, 0xffff0000, v132
    v_cvt_u32_f32 v135, v133
    v_cvt_u32_f32 v136, v134
    v_cvt_f32_u32 v138, v135
    v_cvt_f32_u32 v139, v136
    v_or_b32 v137, v135, v136
    v_cmp_neq_f32 s[92:93], v138, v133
    v_cmp_neq_f32 vcc, v139, v134
    v_sub_u32 v135, 3, v135
    v_sub_u32 v136, 3, v136
    s_or_b64 s[92:93], s[92:93], vcc
    v_mov_b32 v138, 0x00090a0b
    s_mov_b32 s51, 0x00030201
    v_alignbyte_b32 v135, s51, v138, v135
    v_alignbyte_b32 v136, s51, v138, v136
    v_or3_b32 v137, v137, v84, v85
    v_or3_b32 v137, v137, v86, v87
    v_or3_b32 v137, v137, v88, v89
    v_or3_b32 v137, v137, v90, v91
    v_or3_b32 v137, v137, v92, v93
    v_or3_b32 v137, v137, v94, v95
    v_or3_b32 v137, v137, v96, v97
    v_or3_b32 v137, v137, v98, v99
    v_or3_b32 v137, v137, v100, v101
    v_or3_b32 v137, v137, v102, v103
    v_or3_b32 v137, v137, v104, v105
    v_or3_b32 v137, v137, v106, v107
    v_or3_b32 v137, v137, v108, v109
    v_or3_b32 v137, v137, v110, v111
    v_or3_b32 v137, v137, v112, v113
    v_or3_b32 v137, v137, v114, v115
    v_or3_b32 v137, v137, v116, v117
    v_or3_b32 v137, v137, v118, v119
    v_or3_b32 v137, v137, v120, v121
    v_or3_b32 v137, v137, v122, v123
    v_or3_b32 v137, v137, v124, v125
    v_or3_b32 v137, v137, v126, v127
    v_or3_b32 v137, v137, v128, v129
    v_or3_b32 v137, v137, v130, v131
    v_lshl_or_b32 v133, v96, 8, v92
    v_lshl_or_b32 v134, v98, 8, v94
    v_lshl_or_b32 v133, v133, 8, v88
    v_lshl_or_b32 v134, v134, 8, v90
    v_lshl_or_b32 v133, v133, 8, v84
    v_lshl_or_b32 v134, v134, 8, v86
    v_perm_b32 v133, v135, v135, v133
    v_perm_b32 v134, v135, v135, v134
    v_lshl_or_b32 v144, v134, 4, v133
    v_lshl_or_b32 v133, v97, 8, v93
    v_lshl_or_b32 v134, v99, 8, v95
    v_lshl_or_b32 v133, v133, 8, v89
    v_lshl_or_b32 v134, v134, 8, v91
    v_lshl_or_b32 v133, v133, 8, v85
    v_lshl_or_b32 v134, v134, 8, v87
    v_perm_b32 v133, v136, v136, v133
    v_perm_b32 v134, v136, v136, v134
    v_lshl_or_b32 v148, v134, 4, v133
    v_lshl_or_b32 v133, v112, 8, v108
    v_lshl_or_b32 v134, v114, 8, v110
    v_lshl_or_b32 v133, v133, 8, v104
    v_lshl_or_b32 v134, v134, 8, v106
    v_lshl_or_b32 v133, v133, 8, v100
    v_lshl_or_b32 v134, v134, 8, v102
    v_perm_b32 v133, v135, v135, v133
    v_perm_b32 v134, v135, v135, v134
    v_lshl_or_b32 v145, v134, 4, v133
    v_lshl_or_b32 v133, v113, 8, v109
    v_lshl_or_b32 v134, v115, 8, v111
    v_lshl_or_b32 v133, v133, 8, v105
    v_lshl_or_b32 v134, v134, 8, v107
    v_lshl_or_b32 v133, v133, 8, v101
    v_lshl_or_b32 v134, v134, 8, v103
    v_perm_b32 v133, v136, v136, v133
    v_perm_b32 v134, v136, v136, v134
    v_lshl_or_b32 v149, v134, 4, v133
    v_lshl_or_b32 v133, v128, 8, v124
    v_lshl_or_b32 v134, v130, 8, v126
    v_lshl_or_b32 v133, v133, 8, v120
    v_lshl_or_b32 v134, v134, 8, v122
    v_lshl_or_b32 v133, v133, 8, v116
    v_lshl_or_b32 v134, v134, 8, v118
    v_perm_b32 v133, v135, v135, v133
    v_perm_b32 v134, v135, v135, v134
    v_lshl_or_b32 v146, v134, 4, v133
    v_lshl_or_b32 v133, v129, 8, v125
    v_lshl_or_b32 v134, v131, 8, v127
    v_lshl_or_b32 v133, v133, 8, v121
    v_lshl_or_b32 v134, v134, 8, v123
    v_lshl_or_b32 v133, v133, 8, v117
    v_lshl_or_b32 v134, v134, 8, v119
    v_perm_b32 v133, v136, v136, v133
    v_perm_b32 v134, v136, v136, v134
    v_lshl_or_b32 v150, v134, 4, v133
    v_and_b32 v137, 0xfffffffc, v137
    v_cmp_ne_u32 vcc, 0, v137
    v_mov_b32 v147, s53
    v_mov_b32 v151, s53
    s_or_b64 s[92:93], s[92:93], vcc
    s_mov_b32 s72, 0
    s_cmp_lg_u64 s[92:93], 0
    s_cbranch_scc1 K_pubL
    s_mov_b32 s72, 1
    buffer_store_dwordx4 v[144:147], v154, s[40:43], s70 offen sc1
    buffer_store_dwordx4 v[148:151], v155, s[40:43], s70 offen sc1
K_pubL:
    s_waitcnt vmcnt(2)
    s_cmp_eq_u32 s72, 1
    s_cbranch_scc1 K_xin
K_nopub:
    s_waitcnt vmcnt(0)
K_xin:
K_bar:
    s_barrier
    s_add_u32 s64, s62, 0
    s_add_u32 s65, s62, 4096
    s_add_u32 s66, s62, 8192
    buffer_load_dwordx4 v[36:39], v244, s[40:43], s64 offen sc1
    buffer_load_dwordx4 v[40:43], v244, s[40:43], s64 offen offset:1024 sc1
    buffer_load_dwordx4 v[44:47], v244, s[40:43], s64 offen offset:2048 sc1
    buffer_load_dwordx4 v[48:51], v244, s[40:43], s64 offen offset:3072 sc1
    buffer_load_dwordx4 v[52:55], v244, s[40:43], s65 offen sc1
    buffer_load_dwordx4 v[56:59], v244, s[40:43], s65 offen offset:1024 sc1
    buffer_load_dwordx4 v[60:63], v244, s[40:43], s65 offen offset:2048 sc1
    buffer_load_dwordx4 v[64:67], v244, s[40:43], s65 offen offset:3072 sc1
    buffer_load_dwordx4 v[68:71], v244, s[40:43], s66 offen sc1
    buffer_load_dwordx4 v[72:75], v244, s[40:43], s66 offen offset:1024 sc1
    buffer_load_dwordx4 v[76:79], v244, s[40:43], s66 offen offset:2048 sc1
    buffer_load_dwordx4 v[80:83], v244, s[40:43], s66 offen offset:3072 sc1
    v_mov_b32 v217, v154
    v_mov_b32 v218, v155
    s_cmp_eq_u32 s15, 0
    s_cbranch_scc1 K_nodef
    buffer_load_dword v216, v153, s[32:35], s71 offen
    buffer_load_dwordx2 v[164:165], v152, s[24:27], s69 offen nt
    buffer_load_dwordx2 v[166:167], v156, s[24:27], s69 offen nt
    buffer_load_dwordx2 v[168:169], v157, s[24:27], s69 offen nt
    buffer_load_dwordx2 v[170:171], v158, s[24:27], s69 offen nt
    buffer_load_dwordx2 v[172:173], v159, s[24:27], s69 offen nt
    buffer_load_dwordx2 v[174:175], v160, s[24:27], s69 offen nt
    buffer_load_dwordx2 v[176:177], v161, s[24:27], s69 offen nt
    buffer_load_dwordx2 v[178:179], v162, s[24:27], s69 offen nt
    s_add_u32 s69, s69, 589824
    buffer_load_dwordx2 v[180:181], v152, s[24:27], s69 offen nt
    buffer_load_dwordx2 v[182:183], v156, s[24:27], s69 offen nt
    buffer_load_dwordx2 v[184:185], v157, s[24:27], s69 offen nt
    buffer_load_dwordx2 v[186:187], v158, s[24:27], s69 offen nt
    buffer_load_dwordx2 v[188:189], v159, s[24:27], s69 offen nt
    buffer_load_dwordx2 v[190:191], v160, s[24:27], s69 offen nt
    buffer_load_dwordx2 v[192:193], v161, s[24:27], s69 offen nt
    buffer_load_dwordx2 v[194:195], v162, s[24:27], s69 offen nt
    s_add_u32 s69, s69, 589824
    buffer_load_dwordx2 v[224:225], v152, s[24:27], s69 offen nt
    buffer_load_dwordx2 v[226:227], v156, s[24:27], s69 offen nt
    buffer_load_dwordx2 v[228:229], v157, s[24:27], s69 offen nt
    buffer_load_dwordx2 v[230:231], v158, s[24:27], s69 offen nt
    buffer_load_dwordx2 v[232:233], v159, s[24:27], s69 offen nt
    buffer_load_dwordx2 v[234:235], v160, s[24:27], s69 offen nt
    buffer_load_dwordx2 v[236:237], v161, s[24:27], s69 offen nt
    buffer_load_dwordx2 v[238:239], v162, s[24:27], s69 offen nt
K_nodef:
    ds_read_b128 a[0:3], v240 offset:0
    ds_read_b128 a[4:7], v240 offset:18432
    ds_read_b128 a[8:11], v240 offset:36864
    ds_read_b128 a[12:15], v240 offset:55296
    ds_read_b128 a[16:19], v241 offset:0
    ds_read_b128 a[20:23], v241 offset:18432
    ds_read_b128 a[24:27], v241 offset:36864
    ds_read_b128 a[28:31], v241 offset:55296
    ds_read_b128 a[32:35], v240 offset:128
    ds_read_b128 a[36:39], v240 offset:18560
    ds_read_b128 a[40:43], v240 offset:36992
    ds_read_b128 a[44:47], v240 offset:55424
    ds_read_b128 a[48:51], v241 offset:128
    ds_read_b128 a[52:55], v241 offset:18560
    ds_read_b128 a[56:59], v241 offset:36992
    ds_read_b128 a[60:63], v241 offset:55424
    ds_read_b128 a[64:67], v240 offset:256
    ds_read_b128 a[68:71], v240 offset:18688
    ds_read_b128 a[72:75], v240 offset:37120
    ds_read_b128 a[76:79], v240 offset:55552
    ds_read_b128 a[80:83], v241 offset:256
    ds_read_b128 a[84:87], v241 offset:18688
    ds_read_b128 a[88:91], v241 offset:37120
    ds_read_b128 a[92:95], v241 offset:55552
    s_waitcnt vmcnt(25)
    s_cmp_lg_u32 s15, 0
    s_cbranch_scc1 K_w25
    s_waitcnt vmcnt(0)
K_w25:
    v_xad_u32 v249, v39, s53, 0
    v_xad_u32 v249, v43, s53, v249
    v_xad_u32 v249, v47, s53, v249
    v_xad_u32 v249, v51, s53, v249
    v_xad_u32 v249, v55, s53, v249
    v_xad_u32 v249, v59, s53, v249
    v_xad_u32 v249, v63, s53, v249
    v_xad_u32 v249, v67, s53, v249
    v_xad_u32 v249, v71, s53, v249
    v_xad_u32 v249, v75, s53, v249
    v_xad_u32 v249, v79, s53, v249
    v_xad_u32 v249, v83, s53, v249
    v_cmp_ne_u32 vcc, 0, v249
    s_cbranch_vccz K_back0
K_acq0:
    s_mov_b32 s55, 0
    s_add_u32 s64, s62, 0
    s_add_u32 s65, s62, 4096
    s_add_u32 s66, s62, 8192
K_acq0_loop:
    buffer_load_dword v3, v0, s[40:43], s64 offen sc1
    s_waitcnt vmcnt(0)
    v_cmp_ne_u32 vcc, s53, v3
    s_cbranch_vccnz K_acq0_loop_again
K_acq0_loop_full:
    buffer_load_dwordx4 v[36:39], v244, s[40:43], s64 offen sc1
    buffer_load_dwordx4 v[40:43], v244, s[40:43], s64 offen offset:1024 sc1
    buffer_load_dwordx4 v[44:47], v244, s[40:43], s64 offen offset:2048 sc1
    buffer_load_dwordx4 v[48:51], v244, s[40:43], s64 offen offset:3072 sc1
    buffer_load_dwordx4 v[52:55], v244, s[40:43], s65 offen sc1
    buffer_load_dwordx4 v[56:59], v244, s[40:43], s65 offen offset:1024 sc1
    buffer_load_dwordx4 v[60:63], v244, s[40:43], s65 offen offset:2048 sc1
    buffer_load_dwordx4 v[64:67], v244, s[40:43], s65 offen offset:3072 sc1
    buffer_load_dwordx4 v[68:71], v244, s[40:43], s66 offen sc1
    buffer_load_dwordx4 v[72:75], v244, s[40:43], s66 offen offset:1024 sc1
    buffer_load_dwordx4 v[76:79], v244, s[40:43], s66 offen offset:2048 sc1
    buffer_load_dwordx4 v[80:83], v244, s[40:43], s66 offen offset:3072 sc1
    s_waitcnt vmcnt(0)
    v_xad_u32 v249, v39, s53, 0
    v_xad_u32 v249, v43, s53, v249
    v_xad_u32 v249, v47, s53, v249
    v_xad_u32 v249, v51, s53, v249
    v_xad_u32 v249, v55, s53, v249
    v_xad_u32 v249, v59, s53, v249
    v_xad_u32 v249, v63, s53, v249
    v_xad_u32 v249, v67, s53, v249
    v_xad_u32 v249, v71, s53, v249
    v_xad_u32 v249, v75, s53, v249
    v_xad_u32 v249, v79, s53, v249
    v_xad_u32 v249, v83, s53, v249
    v_cmp_ne_u32 vcc, 0, v249
    s_cbranch_vccz K_back0
K_acq0_loop_again:
    s_add_u32 s55, s55, 1
    s_cmp_lt_u32 s55, 4096
    s_cbranch_scc1 K_acq0_loop
    s_branch K_fallback
K_back0:
    v_cvt_scalef32_pk_bf16_fp4 v196, v36, s75 op_sel:[0,0,0]
    v_cvt_scalef32_pk_bf16_fp4 v197, v36, s75 op_sel:[1,0,0]
    v_cvt_scalef32_pk_bf16_fp4 v198, v36, s75 op_sel:[0,1,0]
    v_cvt_scalef32_pk_bf16_fp4 v199, v36, s75 op_sel:[1,1,0]
    v_cvt_scalef32_pk_bf16_fp4 v200, v40, s75 op_sel:[0,0,0]
    v_cvt_scalef32_pk_bf16_fp4 v201, v40, s75 op_sel:[1,0,0]
    v_cvt_scalef32_pk_bf16_fp4 v202, v40, s75 op_sel:[0,1,0]
    v_cvt_scalef32_pk_bf16_fp4 v203, v40, s75 op_sel:[1,1,0]
    s_waitcnt lgkmcnt(0)
    v_mfma_f32_16x16x32_bf16 v[132:135], v[196:199], a[0:3], 0
    v_cvt_scalef32_pk_bf16_fp4 v204, v37, s75 op_sel:[0,0,0]
    v_cvt_scalef32_pk_bf16_fp4 v205, v37, s75 op_sel:[1,0,0]
    v_mfma_f32_16x16x32_bf16 v[136:139], v[196:199], a[4:7], 0
    v_cvt_scalef32_pk_bf16_fp4 v206, v37, s75 op_sel:[0,1,0]
    v_cvt_scalef32_pk_bf16_fp4 v207, v37, s75 op_sel:[1,1,0]
    v_mfma_f32_16x16x32_bf16 v[140:143], v[196:199], a[8:11], 0
    v_cvt_scalef32_pk_bf16_fp4 v208, v41, s75 op_sel:[0,0,0]
    v_cvt_scalef32_pk_bf16_fp4 v209, v41, s75 op_sel:[1,0,0]
    v_mfma_f32_16x16x32_bf16 v[144:147], v[196:199], a[12:15], 0
    v_cvt_scalef32_pk_bf16_fp4 v210, v41, s75 op_sel:[0,1,0]
    v_cvt_scalef32_pk_bf16_fp4 v211, v41, s75 op_sel:[1,1,0]
    v_mfma_f32_16x16x32_bf16 v[148:151], v[200:203], a[0:3], 0
    v_cvt_scalef32_pk_bf16_fp4 v196, v38, s75 op_sel:[0,0,0]
    v_cvt_scalef32_pk_bf16_fp4 v197, v38, s75 op_sel:[1,0,0]
    v_mfma_f32_16x16x32_bf16 v[152:155], v[200:203], a[4:7], 0
    v_cvt_scalef32_pk_bf16_fp4 v198, v38, s75 op_sel:[0,1,0]
    v_cvt_scalef32_pk_bf16_fp4 v199, v38, s75 op_sel:[1,1,0]
    v_mfma_f32_16x16x32_bf16 v[156:159], v[200:203], a[8:11], 0
    ds_read_b128 a[96:99], v240 offset:384
    v_mfma_f32_16x16x32_bf16 v[160:163], v[200:203], a[12:15], 0
    v_cvt_scalef32_pk_bf16_fp4 v200, v42, s75 op_sel:[0,0,0]
    v_cvt_scalef32_pk_bf16_fp4 v201, v42, s75 op_sel:[1,0,0]
    v_mfma_f32_16x16x32_bf16 v[132:135], v[204:207], a[16:19], v[132:135]
    v_cvt_scalef32_pk_bf16_fp4 v202, v42, s75 op_sel:[0,1,0]
    v_cvt_scalef32_pk_bf16_fp4 v203, v42, s75 op_sel:[1,1,0]
    v_mfma_f32_16x16x32_bf16 v[136:139], v[204:207], a[20:23], v[136:139]
    ds_read_b128 a[100:103], v240 offset:18816
    v_mfma_f32_16x16x32_bf16 v[140:143], v[204:207], a[24:27], v[140:143]
    ds_read_b128 a[104:107], v240 offset:37248
    v_mfma_f32_16x16x32_bf16 v[144:147], v[204:207], a[28:31], v[144:147]
    v_cvt_scalef32_pk_bf16_fp4 v204, v44, s75 op_sel:[0,0,0]
    v_cvt_scalef32_pk_bf16_fp4 v205, v44, s75 op_sel:[1,0,0]
    v_mfma_f32_16x16x32_bf16 v[148:151], v[208:211], a[16:19], v[148:151]
    v_cvt_scalef32_pk_bf16_fp4 v206, v44, s75 op_sel:[0,1,0]
    v_cvt_scalef32_pk_bf16_fp4 v207, v44, s75 op_sel:[1,1,0]
    v_mfma_f32_16x16x32_bf16 v[152:155], v[208:211], a[20:23], v[152:155]
    ds_read_b128 a[108:111], v240 offset:55680
    v_mfma_f32_16x16x32_bf16 v[156:159], v[208:211], a[24:27], v[156:159]
    ds_read_b128 a[112:115], v241 offset:384
    v_mfma_f32_16x16x32_bf16 v[160:163], v[208:211], a[28:31], v[160:163]
    v_cvt_scalef32_pk_bf16_fp4 v208, v48, s75 op_sel:[0,0,0]
    v_cvt_scalef32_pk_bf16_fp4 v209, v48, s75 op_sel:[1,0,0]
    v_mfma_f32_16x16x32_bf16 v[132:135], v[196:199], a[32:35], v[132:135]
    v_cvt_scalef32_pk_bf16_fp4 v210, v48, s75 op_sel:[0,1,0]
    v_cvt_scalef32_pk_bf16_fp4 v211, v48, s75 op_sel:[1,1,0]
    v_mfma_f32_16x16x32_bf16 v[136:139], v[196:199], a[36:39], v[136:139]
    ds_read_b128 a[116:119], v241 offset:18816
    v_mfma_f32_16x16x32_bf16 v[140:143], v[196:199], a[40:43], v[140:143]
    ds_read_b128 a[120:123], v241 offset:37248
    v_mfma_f32_16x16x32_bf16 v[144:147], v[196:199], a[44:47], v[144:147]
    v_cvt_scalef32_pk_bf16_fp4 v196, v45, s75 op_sel:[0,0,0]
    v_cvt_scalef32_pk_bf16_fp4 v197, v45, s75 op_sel:[1,0,0]
    v_mfma_f32_16x16x32_bf16 v[148:151], v[200:203], a[32:35], v[148:151]
    s_add_u32 s64, s62, 12288
    s_add_u32 s65, s62, 16384
    v_mfma_f32_16x16x32_bf16 v[152:155], v[200:203], a[36:39], v[152:155]
    s_add_u32 s66, s62, 20480
    v_cvt_scalef32_pk_bf16_fp4 v198, v45, s75 op_sel:[0,1,0]
    v_mfma_f32_16x16x32_bf16 v[156:159], v[200:203], a[40:43], v[156:159]
    v_cvt_scalef32_pk_bf16_fp4 v199, v45, s75 op_sel:[1,1,0]
    v_mfma_f32_16x16x32_bf16 v[160:163], v[200:203], a[44:47], v[160:163]
    v_cvt_scalef32_pk_bf16_fp4 v200, v49, s75 op_sel:[0,0,0]
    v_cvt_scalef32_pk_bf16_fp4 v201, v49, s75 op_sel:[1,0,0]
    v_mfma_f32_16x16x32_bf16 v[132:135], v[204:207], a[48:51], v[132:135]
    v_cvt_scalef32_pk_bf16_fp4 v202, v49, s75 op_sel:[0,1,0]
    v_cvt_scalef32_pk_bf16_fp4 v203, v49, s75 op_sel:[1,1,0]
    v_mfma_f32_16x16x32_bf16 v[136:139], v[204:207], a[52:55], v[136:139]
    buffer_load_dwordx4 v[84:87], v244, s[40:43], s64 offen sc1
    v_mfma_f32_16x16x32_bf16 v[140:143], v[204:207], a[56:59], v[140:143]
    buffer_load_dwordx4 v[88:91], v244, s[40:43], s64 offen offset:1024 sc1
    v_mfma_f32_16x16x32_bf16 v[144:147], v[204:207], a[60:63], v[144:147]
    buffer_load_dwordx4 v[92:95], v244, s[40:43], s64 offen offset:2048 sc1
    v_mfma_f32_16x16x32_bf16 v[148:151], v[208:211], a[48:51], v[148:151]
    v_cvt_scalef32_pk_bf16_fp4 v204, v46, s75 op_sel:[0,0,0]
    v_cvt_scalef32_pk_bf16_fp4 v205, v46, s75 op_sel:[1,0,0]
    v_mfma_f32_16x16x32_bf16 v[152:155], v[208:211], a[52:55], v[152:155]
    buffer_load_dwordx4 v[96:99], v244, s[40:43], s64 offen offset:3072 sc1
    v_mfma_f32_16x16x32_bf16 v[156:159], v[208:211], a[56:59], v[156:159]
    v_cvt_scalef32_pk_bf16_fp4 v206, v46, s75 op_sel:[0,1,0]
    v_cvt_scalef32_pk_bf16_fp4 v207, v46, s75 op_sel:[1,1,0]
    v_mfma_f32_16x16x32_bf16 v[160:163], v[208:211], a[60:63], v[160:163]
    ds_read_b128 a[124:127], v241 offset:55680
    v_mfma_f32_16x16x32_bf16 v[132:135], v[196:199], a[64:67], v[132:135]
    buffer_load_dwordx4 v[100:103], v244, s[40:43], s65 offen sc1
    v_mfma_f32_16x16x32_bf16 v[136:139], v[196:199], a[68:71], v[136:139]
    ds_read_b128 a[128:131], v240 offset:512
    v_mfma_f32_16x16x32_bf16 v[140:143], v[196:199], a[72:75], v[140:143]
    v_cvt_scalef32_pk_bf16_fp4 v208, v50, s75 op_sel:[0,0,0]
    v_cvt_scalef32_pk_bf16_fp4 v209, v50, s75 op_sel:[1,0,0]
    v_mfma_f32_16x16x32_bf16 v[144:147], v[196:199], a[76:79], v[144:147]
    v_cvt_scalef32_pk_bf16_fp4 v210, v50, s75 op_sel:[0,1,0]
    v_cvt_scalef32_pk_bf16_fp4 v211, v50, s75 op_sel:[1,1,0]
    v_mfma_f32_16x16x32_bf16 v[148:151], v[200:203], a[64:67], v[148:151]
    buffer_load_dwordx4 v[104:107], v244, s[40:43], s65 offen offset:1024 sc1
    v_mfma_f32_16x16x32_bf16 v[152:155], v[200:203], a[68:71], v[152:155]
    ds_read_b128 a[132:135], v240 offset:18944
    v_mfma_f32_16x16x32_bf16 v[156:159], v[200:203], a[72:75], v[156:159]
    buffer_load_dwordx4 v[108:111], v244, s[40:43], s65 offen offset:2048 sc1
    v_mfma_f32_16x16x32_bf16 v[160:163], v[200:203], a[76:79], v[160:163]
    ds_read_b128 a[136:139], v240 offset:37376
    v_mfma_f32_16x16x32_bf16 v[132:135], v[204:207], a[80:83], v[132:135]
    v_cvt_scalef32_pk_bf16_fp4 v196, v52, s75 op_sel:[0,0,0]
    v_cvt_scalef32_pk_bf16_fp4 v197, v52, s75 op_sel:[1,0,0]
    v_mfma_f32_16x16x32_bf16 v[136:139], v[204:207], a[84:87], v[136:139]
    v_cvt_scalef32_pk_bf16_fp4 v198, v52, s75 op_sel:[0,1,0]
    v_cvt_scalef32_pk_bf16_fp4 v199, v52, s75 op_sel:[1,1,0]
    v_mfma_f32_16x16x32_bf16 v[140:143], v[204:207], a[88:91], v[140:143]
    buffer_load_dwordx4 v[112:115], v244, s[40:43], s65 offen offset:3072 sc1
    v_mfma_f32_16x16x32_bf16 v[144:147], v[204:207], a[92:95], v[144:147]
    ds_read_b128 a[140:143], v240 offset:55808
    v_mfma_f32_16x16x32_bf16 v[148:151], v[208:211], a[80:83], v[148:151]
    ds_read_b128 a[144:147], v241 offset:512
    v_mfma_f32_16x16x32_bf16 v[152:155], v[208:211], a[84:87], v[152:155]
    s_waitcnt lgkmcnt(9)
    v_cvt_scalef32_pk_bf16_fp4 v200, v56, s75 op_sel:[0,0,0]
    v_mfma_f32_16x16x32_bf16 v[156:159], v[208:211], a[88:91], v[156:159]
    v_cvt_scalef32_pk_bf16_fp4 v201, v56, s75 op_sel:[1,0,0]
    v_cvt_scalef32_pk_bf16_fp4 v202, v56, s75 op_sel:[0,1,0]
    v_mfma_f32_16x16x32_bf16 v[160:163], v[208:211], a[92:95], v[160:163]
    buffer_load_dwordx4 v[116:119], v244, s[40:43], s66 offen sc1
    v_mfma_f32_16x16x32_bf16 v[132:135], v[196:199], a[96:99], v[132:135]
    v_cvt_scalef32_pk_bf16_fp4 v203, v56, s75 op_sel:[1,1,0]
    v_cvt_scalef32_pk_bf16_fp4 v204, v53, s75 op_sel:[0,0,0]
    v_mfma_f32_16x16x32_bf16 v[136:139], v[196:199], a[100:103], v[136:139]
    ds_read_b128 a[148:151], v241 offset:18944
    v_mfma_f32_16x16x32_bf16 v[140:143], v[196:199], a[104:107], v[140:143]
    buffer_load_dwordx4 v[120:123], v244, s[40:43], s66 offen offset:1024 sc1
    v_mfma_f32_16x16x32_bf16 v[144:147], v[196:199], a[108:111], v[144:147]
    ds_read_b128 a[152:155], v241 offset:37376
    v_mfma_f32_16x16x32_bf16 v[148:151], v[200:203], a[96:99], v[148:151]
    v_cvt_scalef32_pk_bf16_fp4 v205, v53, s75 op_sel:[1,0,0]
    v_cvt_scalef32_pk_bf16_fp4 v206, v53, s75 op_sel:[0,1,0]
    v_mfma_f32_16x16x32_bf16 v[152:155], v[200:203], a[100:103], v[152:155]
    buffer_load_dwordx4 v[124:127], v244, s[40:43], s66 offen offset:2048 sc1
    v_cvt_scalef32_pk_bf16_fp4 v207, v53, s75 op_sel:[1,1,0]
    v_mfma_f32_16x16x32_bf16 v[156:159], v[200:203], a[104:107], v[156:159]
    s_waitcnt lgkmcnt(7)
    v_cvt_scalef32_pk_bf16_fp4 v208, v57, s75 op_sel:[0,0,0]
    ds_read_b128 a[156:159], v241 offset:55808
    v_mfma_f32_16x16x32_bf16 v[160:163], v[200:203], a[108:111], v[160:163]
    buffer_load_dwordx4 v[128:131], v244, s[40:43], s66 offen offset:3072 sc1
    v_mfma_f32_16x16x32_bf16 v[132:135], v[204:207], a[112:115], v[132:135]
    ds_read_b128 a[160:163], v240 offset:640
    v_cvt_scalef32_pk_bf16_fp4 v209, v57, s75 op_sel:[1,0,0]
    v_mfma_f32_16x16x32_bf16 v[136:139], v[204:207], a[116:119], v[136:139]
    v_cvt_scalef32_pk_bf16_fp4 v210, v57, s75 op_sel:[0,1,0]
    v_cvt_scalef32_pk_bf16_fp4 v211, v57, s75 op_sel:[1,1,0]
    v_mfma_f32_16x16x32_bf16 v[140:143], v[204:207], a[120:123], v[140:143]
    s_add_u32 s51, s67, 0
    v_cvt_scalef32_pk_bf16_fp4 v196, v54, s75 op_sel:[0,0,0]
    ds_read_b128 a[164:167], v240 offset:19072
    v_mfma_f32_16x16x32_bf16 v[144:147], v[204:207], a[124:127], v[144:147]
    ds_read_b128 a[168:171], v240 offset:37504
    v_mfma_f32_16x16x32_bf16 v[148:151], v[208:211], a[112:115], v[148:151]
    v_cvt_scalef32_pk_bf16_fp4 v197, v54, s75 op_sel:[1,0,0]
    v_cvt_scalef32_pk_bf16_fp4 v198, v54, s75 op_sel:[0,1,0]
    v_mfma_f32_16x16x32_bf16 v[152:155], v[208:211], a[116:119], v[152:155]
    v_cvt_scalef32_pk_bf16_fp4 v199, v54, s75 op_sel:[1,1,0]
    s_waitcnt lgkmcnt(7)
    v_mfma_f32_16x16x32_bf16 v[156:159], v[208:211], a[120:123], v[156:159]
    buffer_load_dwordx4 v[212:215], v246, s[28:31], s51 offen
    ds_read_b128 a[172:175], v240 offset:55936
    v_mfma_f32_16x16x32_bf16 v[160:163], v[208:211], a[124:127], v[160:163]
    ds_read_b128 a[176:179], v241 offset:640
    v_mfma_f32_16x16x32_bf16 v[132:135], v[196:199], a[128:131], v[132:135]
    v_cvt_scalef32_pk_bf16_fp4 v200, v58, s75 op_sel:[0,0,0]
    v_cvt_scalef32_pk_bf16_fp4 v201, v58, s75 op_sel:[1,0,0]
    v_mfma_f32_16x16x32_bf16 v[136:139], v[196:199], a[132:135], v[136:139]
    v_cvt_scalef32_pk_bf16_fp4 v202, v58, s75 op_sel:[0,1,0]
    v_cvt_scalef32_pk_bf16_fp4 v203, v58, s75 op_sel:[1,1,0]
    v_mfma_f32_16x16x32_bf16 v[140:143], v[196:199], a[136:139], v[140:143]
    ds_read_b128 a[180:183], v241 offset:19072
    v_mfma_f32_16x16x32_bf16 v[144:147], v[196:199], a[140:143], v[144:147]
    ds_read_b128 a[184:187], v241 offset:37504
    v_mfma_f32_16x16x32_bf16 v[148:151], v[200:203], a[128:131], v[148:151]
    v_cvt_scalef32_pk_bf16_fp4 v204, v60, s75 op_sel:[0,0,0]
    v_cvt_scalef32_pk_bf16_fp4 v205, v60, s75 op_sel:[1,0,0]
    v_mfma_f32_16x16x32_bf16 v[152:155], v[200:203], a[132:135], v[152:155]
    v_cvt_scalef32_pk_bf16_fp4 v206, v60, s75 op_sel:[0,1,0]
    v_cvt_scalef32_pk_bf16_fp4 v207, v60, s75 op_sel:[1,1,0]
    v_mfma_f32_16x16x32_bf16 v[156:159], v[200:203], a[136:139], v[156:159]
    s_waitcnt lgkmcnt(7)
    v_cvt_scalef32_pk_bf16_fp4 v208, v64, s75 op_sel:[0,0,0]
    ds_read_b128 a[188:191], v241 offset:55936
    v_mfma_f32_16x16x32_bf16 v[160:163], v[200:203], a[140:143], v[160:163]
    ds_read_b128 a[192:195], v240 offset:768
    v_mfma_f32_16x16x32_bf16 v[132:135], v[204:207], a[144:147], v[132:135]
    v_cvt_scalef32_pk_bf16_fp4 v209, v64, s75 op_sel:[1,0,0]
    v_cvt_scalef32_pk_bf16_fp4 v210, v64, s75 op_sel:[0,1,0]
    v_mfma_f32_16x16x32_bf16 v[136:139], v[204:207], a[148:151], v[136:139]
    v_cvt_scalef32_pk_bf16_fp4 v211, v64, s75 op_sel:[1,1,0]
    v_cvt_scalef32_pk_bf16_fp4 v196, v61, s75 op_sel:[0,0,0]
    v_mfma_f32_16x16x32_bf16 v[140:143], v[204:207], a[152:155], v[140:143]
    ds_read_b128 a[196:199], v240 offset:19200
    v_mfma_f32_16x16x32_bf16 v[144:147], v[204:207], a[156:159], v[144:147]
    ds_read_b128 a[200:203], v240 offset:37632
    v_mfma_f32_16x16x32_bf16 v[148:151], v[208:211], a[144:147], v[148:151]
    v_cvt_scalef32_pk_bf16_fp4 v197, v61, s75 op_sel:[1,0,0]
    v_cvt_scalef32_pk_bf16_fp4 v198, v61, s75 op_sel:[0,1,0]
    v_mfma_f32_16x16x32_bf16 v[152:155], v[208:211], a[148:151], v[152:155]
    v_cvt_scalef32_pk_bf16_fp4 v199, v61, s75 op_sel:[1,1,0]
    s_waitcnt lgkmcnt(7)
    v_mfma_f32_16x16x32_bf16 v[156:159], v[208:211], a[152:155], v[156:159]
    ds_read_b128 a[204:207], v240 offset:56064
    v_mfma_f32_16x16x32_bf16 v[160:163], v[208:211], a[156:159], v[160:163]
    ds_read_b128 a[208:211], v241 offset:768
    v_mfma_f32_16x16x32_bf16 v[132:135], v[196:199], a[160:163], v[132:135]
    v_cvt_scalef32_pk_bf16_fp4 v200, v65, s75 op_sel:[0,0,0]
    v_cvt_scalef32_pk_bf16_fp4 v201, v65, s75 op_sel:[1,0,0]
    v_mfma_f32_16x16x32_bf16 v[136:139], v[196:199], a[164:167], v[136:139]
    v_cvt_scalef32_pk_bf16_fp4 v202, v65, s75 op_sel:[0,1,0]
    v_cvt_scalef32_pk_bf16_fp4 v203, v65, s75 op_sel:[1,1,0]
    v_mfma_f32_16x16x32_bf16 v[140:143], v[196:199], a[168:171], v[140:143]
    ds_read_b128 a[212:215], v241 offset:19200
    v_mfma_f32_16x16x32_bf16 v[144:147], v[196:199], a[172:175], v[144:147]
    ds_read_b128 a[216:219], v241 offset:37632
    v_mfma_f32_16x16x32_bf16 v[148:151], v[200:203], a[160:163], v[148:151]
    v_cvt_scalef32_pk_bf16_fp4 v204, v62, s75 op_sel:[0,0,0]
    v_cvt_scalef32_pk_bf16_fp4 v205, v62, s75 op_sel:[1,0,0]
    v_mfma_f32_16x16x32_bf16 v[152:155], v[200:203], a[164:167], v[152:155]
    v_cvt_scalef32_pk_bf16_fp4 v206, v62, s75 op_sel:[0,1,0]
    v_cvt_scalef32_pk_bf16_fp4 v207, v62, s75 op_sel:[1,1,0]
    v_mfma_f32_16x16x32_bf16 v[156:159], v[200:203], a[168:171], v[156:159]
    s_waitcnt lgkmcnt(7)
    v_cvt_scalef32_pk_bf16_fp4 v208, v66, s75 op_sel:[0,0,0]
    ds_read_b128 a[220:223], v241 offset:56064
    v_mfma_f32_16x16x32_bf16 v[160:163], v[200:203], a[172:175], v[160:163]
    ds_read_b128 a[224:227], v240 offset:896
    v_mfma_f32_16x16x32_bf16 v[132:135], v[204:207], a[176:179], v[132:135]
    v_cvt_scalef32_pk_bf16_fp4 v209, v66, s75 op_sel:[1,0,0]
    v_cvt_scalef32_pk_bf16_fp4 v210, v66, s75 op_sel:[0,1,0]
    v_mfma_f32_16x16x32_bf16 v[136:139], v[204:207], a[180:183], v[136:139]
    v_cvt_scalef32_pk_bf16_fp4 v211, v66, s75 op_sel:[1,1,0]
    v_cvt_scalef32_pk_bf16_fp4 v196, v68, s75 op_sel:[0,0,0]
    v_mfma_f32_16x16x32_bf16 v[140:143], v[204:207], a[184:187], v[140:143]
    ds_read_b128 a[228:231], v240 offset:19328
    v_mfma_f32_16x16x32_bf16 v[144:147], v[204:207], a[188:191], v[144:147]
    ds_read_b128 a[232:235], v240 offset:37760
    v_mfma_f32_16x16x32_bf16 v[148:151], v[208:211], a[176:179], v[148:151]
    v_cvt_scalef32_pk_bf16_fp4 v197, v68, s75 op_sel:[1,0,0]
    v_cvt_scalef32_pk_bf16_fp4 v198, v68, s75 op_sel:[0,1,0]
    v_mfma_f32_16x16x32_bf16 v[152:155], v[208:211], a[180:183], v[152:155]
    v_cvt_scalef32_pk_bf16_fp4 v199, v68, s75 op_sel:[1,1,0]
    s_waitcnt lgkmcnt(7)
    v_mfma_f32_16x16x32_bf16 v[156:159], v[208:211], a[184:187], v[156:159]
    ds_read_b128 a[236:239], v240 offset:56192
    v_mfma_f32_16x16x32_bf16 v[160:163], v[208:211], a[188:191], v[160:163]
    ds_read_b128 a[240:243], v241 offset:896
    v_mfma_f32_16x16x32_bf16 v[132:135], v[196:199], a[192:195], v[132:135]
    v_cvt_scalef32_pk_bf16_fp4 v200, v72, s75 op_sel:[0,0,0]
    v_cvt_scalef32_pk_bf16_fp4 v201, v72, s75 op_sel:[1,0,0]
    v_mfma_f32_16x16x32_bf16 v[136:139], v[196:199], a[196:199], v[136:139]
    v_cvt_scalef32_pk_bf16_fp4 v202, v72, s75 op_sel:[0,1,0]
    v_cvt_scalef32_pk_bf16_fp4 v203, v72, s75 op_sel:[1,1,0]
    v_mfma_f32_16x16x32_bf16 v[140:143], v[196:199], a[200:203], v[140:143]
    ds_read_b128 a[244:247], v241 offset:19328
    v_mfma_f32_16x16x32_bf16 v[144:147], v[196:199], a[204:207], v[144:147]
    ds_read_b128 a[248:251], v241 offset:37760
    v_mfma_f32_16x16x32_bf16 v[148:151], v[200:203], a[192:195], v[148:151]
    v_cvt_scalef32_pk_bf16_fp4 v204, v69, s75 op_sel:[0,0,0]
    v_cvt_scalef32_pk_bf16_fp4 v205, v69, s75 op_sel:[1,0,0]
    v_mfma_f32_16x16x32_bf16 v[152:155], v[200:203], a[196:199], v[152:155]
    v_cvt_scalef32_pk_bf16_fp4 v206, v69, s75 op_sel:[0,1,0]
    v_cvt_scalef32_pk_bf16_fp4 v207, v69, s75 op_sel:[1,1,0]
    v_mfma_f32_16x16x32_bf16 v[156:159], v[200:203], a[200:203], v[156:159]
    s_waitcnt lgkmcnt(7)
    v_cvt_scalef32_pk_bf16_fp4 v208, v73, s75 op_sel:[0,0,0]
    ds_read_b128 a[252:255], v241 offset:56192
    v_mfma_f32_16x16x32_bf16 v[160:163], v[200:203], a[204:207], v[160:163]
    ds_read_b128 v[4:7], v240 offset:1024
    v_mfma_f32_16x16x32_bf16 v[132:135], v[204:207], a[208:211], v[132:135]
    v_cvt_scalef32_pk_bf16_fp4 v209, v73, s75 op_sel:[1,0,0]
    v_cvt_scalef32_pk_bf16_fp4 v210, v73, s75 op_sel:[0,1,0]
    v_mfma_f32_16x16x32_bf16 v[136:139], v[204:207], a[212:215], v[136:139]
    v_cvt_scalef32_pk_bf16_fp4 v211, v73, s75 op_sel:[1,1,0]
    v_cvt_scalef32_pk_bf16_fp4 v196, v70, s75 op_sel:[0,0,0]
    v_mfma_f32_16x16x32_bf16 v[140:143], v[204:207], a[216:219], v[140:143]
    ds_read_b128 v[8:11], v240 offset:19456
    v_mfma_f32_16x16x32_bf16 v[144:147], v[204:207], a[220:223], v[144:147]
    ds_read_b128 v[12:15], v240 offset:37888
    v_mfma_f32_16x16x32_bf16 v[148:151], v[208:211], a[208:211], v[148:151]
    v_cvt_scalef32_pk_bf16_fp4 v197, v70, s75 op_sel:[1,0,0]
    v_cvt_scalef32_pk_bf16_fp4 v198, v70, s75 op_sel:[0,1,0]
    v_mfma_f32_16x16x32_bf16 v[152:155], v[208:211], a[212:215], v[152:155]
    v_cvt_scalef32_pk_bf16_fp4 v199, v70, s75 op_sel:[1,1,0]
    s_waitcnt lgkmcnt(7)
    v_mfma_f32_16x16x32_bf16 v[156:159], v[208:211], a[216:219], v[156:159]
    ds_read_b128 v[16:19], v240 offset:56320
    v_mfma_f32_16x16x32_bf16 v[160:163], v[208:211], a[220:223], v[160:163]
    ds_read_b128 v[20:23], v241 offset:1024
    v_mfma_f32_16x16x32_bf16 v[132:135], v[196:199], a[224:227], v[132:135]
    v_cvt_scalef32_pk_bf16_fp4 v200, v74, s75 op_sel:[0,0,0]
    v_cvt_scalef32_pk_bf16_fp4 v201, v74, s75 op_sel:[1,0,0]
    v_mfma_f32_16x16x32_bf16 v[136:139], v[196:199], a[228:231], v[136:139]
    v_cvt_scalef32_pk_bf16_fp4 v202, v74, s75 op_sel:[0,1,0]
    v_cvt_scalef32_pk_bf16_fp4 v203, v74, s75 op_sel:[1,1,0]
    v_mfma_f32_16x16x32_bf16 v[140:143], v[196:199], a[232:235], v[140:143]
    ds_read_b128 v[24:27], v241 offset:19456
    v_mfma_f32_16x16x32_bf16 v[144:147], v[196:199], a[236:239], v[144:147]
    ds_read_b128 v[28:31], v241 offset:37888
    v_mfma_f32_16x16x32_bf16 v[148:151], v[200:203], a[224:227], v[148:151]
    v_cvt_scalef32_pk_bf16_fp4 v204, v76, s75 op_sel:[0,0,0]
    v_cvt_scalef32_pk_bf16_fp4 v205, v76, s75 op_sel:[1,0,0]
    v_mfma_f32_16x16x32_bf16 v[152:155], v[200:203], a[228:231], v[152:155]
    v_cvt_scalef32_pk_bf16_fp4 v206, v76, s75 op_sel:[0,1,0]
    v_cvt_scalef32_pk_bf16_fp4 v207, v76, s75 op_sel:[1,1,0]
    v_mfma_f32_16x16x32_bf16 v[156:159], v[200:203], a[232:235], v[156:159]
    s_waitcnt lgkmcnt(7)
    v_cvt_scalef32_pk_bf16_fp4 v208, v80, s75 op_sel:[0,0,0]
    ds_read_b128 v[32:35], v241 offset:56320
    v_mfma_f32_16x16x32_bf16 v[160:163], v[200:203], a[236:239], v[160:163]
    v_cvt_scalef32_pk_bf16_fp4 v209, v80, s75 op_sel:[1,0,0]
    v_cvt_scalef32_pk_bf16_fp4 v210, v80, s75 op_sel:[0,1,0]
    v_mfma_f32_16x16x32_bf16 v[132:135], v[204:207], a[240:243], v[132:135]
    v_cvt_scalef32_pk_bf16_fp4 v211, v80, s75 op_sel:[1,1,0]
    s_waitcnt vmcnt(0)
    v_mfma_f32_16x16x32_bf16 v[136:139], v[204:207], a[244:247], v[136:139]
    v_xad_u32 v249, v87, s53, 0
    v_cvt_scalef32_pk_bf16_fp4 v196, v77, s75 op_sel:[0,0,0]
    v_mfma_f32_16x16x32_bf16 v[140:143], v[204:207], a[248:251], v[140:143]
    v_cvt_scalef32_pk_bf16_fp4 v197, v77, s75 op_sel:[1,0,0]
    v_xad_u32 v249, v91, s53, v249
    v_mfma_f32_16x16x32_bf16 v[144:147], v[204:207], a[252:255], v[144:147]
    v_cvt_scalef32_pk_bf16_fp4 v198, v77, s75 op_sel:[0,1,0]
    v_cvt_scalef32_pk_bf16_fp4 v199, v77, s75 op_sel:[1,1,0]
    v_mfma_f32_16x16x32_bf16 v[148:151], v[208:211], a[240:243], v[148:151]
    v_xad_u32 v249, v95, s53, v249
    v_cvt_scalef32_pk_bf16_fp4 v200, v81, s75 op_sel:[0,0,0]
    v_mfma_f32_16x16x32_bf16 v[152:155], v[208:211], a[244:247], v[152:155]
    s_waitcnt lgkmcnt(4)
    v_cvt_scalef32_pk_bf16_fp4 v201, v81, s75 op_sel:[1,0,0]
    v_mfma_f32_16x16x32_bf16 v[156:159], v[208:211], a[248:251], v[156:159]
    v_xad_u32 v249, v99, s53, v249
    v_cvt_scalef32_pk_bf16_fp4 v202, v81, s75 op_sel:[0,1,0]
    v_mfma_f32_16x16x32_bf16 v[160:163], v[208:211], a[252:255], v[160:163]
    v_cvt_scalef32_pk_bf16_fp4 v203, v81, s75 op_sel:[1,1,0]
    v_xad_u32 v249, v103, s53, v249
    v_mfma_f32_16x16x32_bf16 v[132:135], v[196:199], v[4:7], v[132:135]
    v_xad_u32 v249, v107, s53, v249
    v_xad_u32 v249, v111, s53, v249
    v_mfma_f32_16x16x32_bf16 v[136:139], v[196:199], v[8:11], v[136:139]
    v_xad_u32 v249, v115, s53, v249
    v_xad_u32 v249, v119, s53, v249
    v_mfma_f32_16x16x32_bf16 v[140:143], v[196:199], v[12:15], v[140:143]
    v_xad_u32 v249, v123, s53, v249
    v_xad_u32 v249, v127, s53, v249
    v_mfma_f32_16x16x32_bf16 v[144:147], v[196:199], v[16:19], v[144:147]
    v_xad_u32 v249, v131, s53, v249
    v_cvt_scalef32_pk_bf16_fp4 v204, v78, s75 op_sel:[0,0,0]
    v_mfma_f32_16x16x32_bf16 v[148:151], v[200:203], v[4:7], v[148:151]
    v_cvt_scalef32_pk_bf16_fp4 v205, v78, s75 op_sel:[1,0,0]
    v_cmp_ne_u32 vcc, 0, v249
    v_mfma_f32_16x16x32_bf16 v[152:155], v[200:203], v[8:11], v[152:155]
    v_cvt_scalef32_pk_bf16_fp4 v206, v78, s75 op_sel:[0,1,0]
    v_cvt_scalef32_pk_bf16_fp4 v207, v78, s75 op_sel:[1,1,0]
    v_mfma_f32_16x16x32_bf16 v[156:159], v[200:203], v[12:15], v[156:159]
    s_waitcnt lgkmcnt(0)
    s_cbranch_vccnz K_retry1
K_back1:
    v_mfma_f32_16x16x32_bf16 v[160:163], v[200:203], v[16:19], v[160:163]
    v_cvt_scalef32_pk_bf16_fp4 v208, v82, s75 op_sel:[0,0,0]
    v_cvt_scalef32_pk_bf16_fp4 v209, v82, s75 op_sel:[1,0,0]
    v_mfma_f32_16x16x32_bf16 v[132:135], v[204:207], v[20:23], v[132:135]
    v_cvt_scalef32_pk_bf16_fp4 v210, v82, s75 op_sel:[0,1,0]
    v_cvt_scalef32_pk_bf16_fp4 v211, v82, s75 op_sel:[1,1,0]
    v_mfma_f32_16x16x32_bf16 v[136:139], v[204:207], v[24:27], v[136:139]
    v_cvt_scalef32_pk_bf16_fp4 v196, v84, s75 op_sel:[0,0,0]
    v_cvt_scalef32_pk_bf16_fp4 v197, v84, s75 op_sel:[1,0,0]
    v_mfma_f32_16x16x32_bf16 v[140:143], v[204:207], v[28:31], v[140:143]
    v_cvt_scalef32_pk_bf16_fp4 v198, v84, s75 op_sel:[0,1,0]
    v_cvt_scalef32_pk_bf16_fp4 v199, v84, s75 op_sel:[1,1,0]
    v_mfma_f32_16x16x32_bf16 v[144:147], v[204:207], v[32:35], v[144:147]
    v_cvt_scalef32_pk_bf16_fp4 v200, v88, s75 op_sel:[0,0,0]
    v_cvt_scalef32_pk_bf16_fp4 v201, v88, s75 op_sel:[1,0,0]
    v_mfma_f32_16x16x32_bf16 v[148:151], v[208:211], v[20:23], v[148:151]
    v_cvt_scalef32_pk_bf16_fp4 v202, v88, s75 op_sel:[0,1,0]
    v_cvt_scalef32_pk_bf16_fp4 v203, v88, s75 op_sel:[1,1,0]
    v_mfma_f32_16x16x32_bf16 v[152:155], v[208:211], v[24:27], v[152:155]
    v_cvt_scalef32_pk_bf16_fp4 v204, v85, s75 op_sel:[0,0,0]
    v_cvt_scalef32_pk_bf16_fp4 v205, v85, s75 op_sel:[1,0,0]
    v_mfma_f32_16x16x32_bf16 v[156:159], v[208:211], v[28:31], v[156:159]
    v_cvt_scalef32_pk_bf16_fp4 v206, v85, s75 op_sel:[0,1,0]
    v_cvt_scalef32_pk_bf16_fp4 v207, v85, s75 op_sel:[1,1,0]
    v_mfma_f32_16x16x32_bf16 v[160:163], v[208:211], v[32:35], v[160:163]
    v_cvt_scalef32_pk_bf16_fp4 v208, v89, s75 op_sel:[0,0,0]
    v_cvt_scalef32_pk_bf16_fp4 v209, v89, s75 op_sel:[1,0,0]
    s_cmp_eq_u32 s15, 0
    s_cbranch_scc1 K_defdone
    v_lshlrev_b32 v219, 16, v216
    v_and_b32 v220, 0xffff0000, v216
    v_cvt_u32_f32 v221, v219
    v_cvt_u32_f32 v222, v220
    v_cvt_f32_u32 v3, v221
    v_cvt_f32_u32 v255, v222
    v_or_b32 v223, v221, v222
    v_cmp_neq_f32 s[92:93], v3, v219
    v_cmp_neq_f32 vcc, v255, v220
    v_sub_u32 v221, 3, v221
    v_sub_u32 v222, 3, v222
    s_or_b64 s[92:93], s[92:93], vcc
    v_mov_b32 v3, 0x00090a0b
    s_mov_b32 s51, 0x00030201
    v_alignbyte_b32 v221, s51, v3, v221
    v_alignbyte_b32 v222, s51, v3, v222
    v_or3_b32 v223, v223, v164, v165
    v_or3_b32 v223, v223, v166, v167
    v_or3_b32 v223, v223, v168, v169
    v_or3_b32 v223, v223, v170, v171
    v_or3_b32 v223, v223, v172, v173
    v_or3_b32 v223, v223, v174, v175
    v_or3_b32 v223, v223, v176, v177
    v_or3_b32 v223, v223, v178, v179
    v_or3_b32 v223, v223, v180, v181
    v_or3_b32 v223, v223, v182, v183
    v_or3_b32 v223, v223, v184, v185
    v_or3_b32 v223, v223, v186, v187
    v_or3_b32 v223, v223, v188, v189
    v_or3_b32 v223, v223, v190, v191
    v_or3_b32 v223, v223, v192, v193
    v_or3_b32 v223, v223, v194, v195
    v_or3_b32 v223, v223, v224, v225
    v_or3_b32 v223, v223, v226, v227
    v_or3_b32 v223, v223, v228, v229
    v_or3_b32 v223, v223, v230, v231
    v_or3_b32 v223, v223, v232, v233
    v_or3_b32 v223, v223, v234, v235
    v_or3_b32 v223, v223, v236, v237
    v_or3_b32 v223, v223, v238, v239
    v_lshl_or_b32 v219, v176, 8, v172
    v_lshl_or_b32 v220, v178, 8, v174
    v_lshl_or_b32 v219, v219, 8, v168
    v_lshl_or_b32 v220, v220, 8, v170
    v_lshl_or_b32 v219, v219, 8, v164
    v_lshl_or_b32 v220, v220, 8, v166
    v_perm_b32 v219, v221, v221, v219
    v_perm_b32 v220, v221, v221, v220
    v_lshl_or_b32 v164, v220, 4, v219
    v_lshl_or_b32 v219, v177, 8, v173
    v_lshl_or_b32 v220, v179, 8, v175
    v_lshl_or_b32 v219, v219, 8, v169
    v_lshl_or_b32 v220, v220, 8, v171
    v_lshl_or_b32 v219, v219, 8, v165
    v_lshl_or_b32 v220, v220, 8, v167
    v_perm_b32 v219, v222, v222, v219
    v_perm_b32 v220, v222, v222, v220
    v_lshl_or_b32 v168, v220, 4, v219
    v_lshl_or_b32 v219, v192, 8, v188
    v_lshl_or_b32 v220, v194, 8, v190
    v_lshl_or_b32 v219, v219, 8, v184
    v_lshl_or_b32 v220, v220, 8, v186
    v_lshl_or_b32 v219, v219, 8, v180
    v_lshl_or_b32 v220, v220, 8, v182
    v_perm_b32 v219, v221, v221, v219
    v_perm_b32 v220, v221, v221, v220
    v_lshl_or_b32 v165, v220, 4, v219
    v_lshl_or_b32 v219, v193, 8, v189
    v_lshl_or_b32 v220, v195, 8, v191
    v_lshl_or_b32 v219, v219, 8, v185
    v_lshl_or_b32 v220, v220, 8, v187
    v_lshl_or_b32 v219, v219, 8, v181
    v_lshl_or_b32 v220, v220, 8, v183
    v_perm_b32 v219, v222, v222, v219
    v_perm_b32 v220, v222, v222, v220
    v_lshl_or_b32 v169, v220, 4, v219
    v_lshl_or_b32 v219, v236, 8, v232
    v_lshl_or_b32 v220, v238, 8, v234
    v_lshl_or_b32 v219, v219, 8, v228
    v_lshl_or_b32 v220, v220, 8, v230
    v_lshl_or_b32 v219, v219, 8, v224
    v_lshl_or_b32 v220, v220, 8, v226
    v_perm_b32 v219, v221, v221, v219
    v_perm_b32 v220, v221, v221, v220
    v_lshl_or_b32 v166, v220, 4, v219
    v_lshl_or_b32 v219, v237, 8, v233
    v_lshl_or_b32 v220, v239, 8, v235
    v_lshl_or_b32 v219, v219, 8, v229
    v_lshl_or_b32 v220, v220, 8, v231
    v_lshl_or_b32 v219, v219, 8, v225
    v_lshl_or_b32 v220, v220, 8, v227
    v_perm_b32 v219, v222, v222, v219
    v_perm_b32 v220, v222, v222, v220
    v_lshl_or_b32 v170, v220, 4, v219
    v_and_b32 v223, 0xfffffffc, v223
    v_cmp_ne_u32 vcc, 0, v223
    v_mov_b32 v167, s53
    v_mov_b32 v171, s53
    s_or_b64 s[92:93], s[92:93], vcc
    s_mov_b32 s72, 0
    s_cmp_lg_u64 s[92:93], 0
    s_cbranch_scc1 K_defdone
    s_mov_b32 s72, 1
    buffer_store_dwordx4 v[164:167], v217, s[40:43], s70 offen sc1
    buffer_store_dwordx4 v[168:171], v218, s[40:43], s70 offen sc1
K_defdone:
    s_nop 1
    v_mfma_f32_16x16x32_bf16 v[164:167], v[196:199], a[0:3], 0
    s_add_u32 s64, s62, 98304
    s_add_u32 s65, s62, 102400
    v_mfma_f32_16x16x32_bf16 v[168:171], v[196:199], a[4:7], 0
    s_add_u32 s66, s62, 106496
    v_cvt_scalef32_pk_bf16_fp4 v210, v89, s75 op_sel:[0,1,0]
    v_mfma_f32_16x16x32_bf16 v[172:175], v[196:199], a[8:11], 0
    buffer_load_dwordx4 v[36:39], v244, s[40:43], s64 offen sc1
    v_mfma_f32_16x16x32_bf16 v[176:179], v[196:199], a[12:15], 0
    v_cvt_scalef32_pk_bf16_fp4 v211, v89, s75 op_sel:[1,1,0]
    v_lshlrev_b32 v216, 16, v212
    v_mfma_f32_16x16x32_bf16 v[180:183], v[200:203], a[0:3], 0
    buffer_load_dwordx4 v[40:43], v244, s[40:43], s64 offen offset:1024 sc1
    v_mfma_f32_16x16x32_bf16 v[184:187], v[200:203], a[4:7], 0
    v_and_b32 v220, 0xffff0000, v212
    v_lshlrev_b32 v217, 16, v213
    v_mfma_f32_16x16x32_bf16 v[188:191], v[200:203], a[8:11], 0
    v_and_b32 v221, 0xffff0000, v213
    v_lshlrev_b32 v218, 16, v214
    v_mfma_f32_16x16x32_bf16 v[192:195], v[200:203], a[12:15], 0
    v_and_b32 v222, 0xffff0000, v214
    v_lshlrev_b32 v219, 16, v215
    v_mfma_f32_16x16x32_bf16 v[164:167], v[204:207], a[16:19], v[164:167]
    v_and_b32 v223, 0xffff0000, v215
    v_mul_f32 v132, v132, v216
    v_mfma_f32_16x16x32_bf16 v[168:171], v[204:207], a[20:23], v[168:171]
    v_mul_f32 v148, v148, v220
    v_mul_f32 v133, v133, v217
    v_mfma_f32_16x16x32_bf16 v[172:175], v[204:207], a[24:27], v[172:175]
    v_cvt_scalef32_pk_bf16_fp4 v196, v86, s75 op_sel:[0,0,0]
    v_cvt_scalef32_pk_bf16_fp4 v197, v86, s75 op_sel:[1,0,0]
    v_mfma_f32_16x16x32_bf16 v[176:179], v[204:207], a[28:31], v[176:179]
    v_cvt_scalef32_pk_bf16_fp4 v198, v86, s75 op_sel:[0,1,0]
    v_cvt_scalef32_pk_bf16_fp4 v199, v86, s75 op_sel:[1,1,0]
    v_mfma_f32_16x16x32_bf16 v[180:183], v[208:211], a[16:19], v[180:183]
    buffer_load_dwordx4 v[44:47], v244, s[40:43], s64 offen offset:2048 sc1
    v_mfma_f32_16x16x32_bf16 v[184:187], v[208:211], a[20:23], v[184:187]
    v_mul_f32 v149, v149, v221
    v_mul_f32 v134, v134, v218
    v_mfma_f32_16x16x32_bf16 v[188:191], v[208:211], a[24:27], v[188:191]
    v_cvt_scalef32_pk_bf16_fp4 v200, v90, s75 op_sel:[0,0,0]
    v_cvt_scalef32_pk_bf16_fp4 v201, v90, s75 op_sel:[1,0,0]
    v_mfma_f32_16x16x32_bf16 v[192:195], v[208:211], a[28:31], v[192:195]
    v_cvt_scalef32_pk_bf16_fp4 v202, v90, s75 op_sel:[0,1,0]
    v_cvt_scalef32_pk_bf16_fp4 v203, v90, s75 op_sel:[1,1,0]
    v_mfma_f32_16x16x32_bf16 v[164:167], v[196:199], a[32:35], v[164:167]
    buffer_load_dwordx4 v[48:51], v244, s[40:43], s64 offen offset:3072 sc1
    v_mfma_f32_16x16x32_bf16 v[168:171], v[196:199], a[36:39], v[168:171]
    v_mul_f32 v150, v150, v222
    v_mul_f32 v135, v135, v219
    v_mfma_f32_16x16x32_bf16 v[172:175], v[196:199], a[40:43], v[172:175]
    v_cvt_scalef32_pk_bf16_fp4 v204, v92, s75 op_sel:[0,0,0]
    v_cvt_scalef32_pk_bf16_fp4 v205, v92, s75 op_sel:[1,0,0]
    v_mfma_f32_16x16x32_bf16 v[176:179], v[196:199], a[44:47], v[176:179]
    buffer_load_dwordx4 v[52:55], v244, s[40:43], s65 offen sc1
    v_mfma_f32_16x16x32_bf16 v[180:183], v[200:203], a[32:35], v[180:183]
    v_cvt_scalef32_pk_bf16_fp4 v206, v92, s75 op_sel:[0,1,0]
    v_cvt_scalef32_pk_bf16_fp4 v207, v92, s75 op_sel:[1,1,0]
    v_mfma_f32_16x16x32_bf16 v[184:187], v[200:203], a[36:39], v[184:187]
    v_mul_f32 v151, v151, v223
    v_cvt_pk_bf16_f32 v224, v132, v148
    v_mfma_f32_16x16x32_bf16 v[188:191], v[200:203], a[40:43], v[188:191]
    v_cvt_scalef32_pk_bf16_fp4 v208, v96, s75 op_sel:[0,0,0]
    v_cvt_scalef32_pk_bf16_fp4 v209, v96, s75 op_sel:[1,0,0]
    v_mfma_f32_16x16x32_bf16 v[192:195], v[200:203], a[44:47], v[192:195]
    buffer_load_dwordx4 v[56:59], v244, s[40:43], s65 offen offset:1024 sc1
    v_mfma_f32_16x16x32_bf16 v[164:167], v[204:207], a[48:51], v[164:167]
    v_cvt_scalef32_pk_bf16_fp4 v210, v96, s75 op_sel:[0,1,0]
    v_cvt_scalef32_pk_bf16_fp4 v211, v96, s75 op_sel:[1,1,0]
    v_mfma_f32_16x16x32_bf16 v[168:171], v[204:207], a[52:55], v[168:171]
    v_cvt_pk_bf16_f32 v225, v133, v149
    v_cvt_pk_bf16_f32 v226, v134, v150
    v_mfma_f32_16x16x32_bf16 v[172:175], v[204:207], a[56:59], v[172:175]
    v_cvt_scalef32_pk_bf16_fp4 v196, v93, s75 op_sel:[0,0,0]
    v_cvt_scalef32_pk_bf16_fp4 v197, v93, s75 op_sel:[1,0,0]
    v_mfma_f32_16x16x32_bf16 v[176:179], v[204:207], a[60:63], v[176:179]
    buffer_load_dwordx4 v[60:63], v244, s[40:43], s65 offen offset:2048 sc1
    v_mfma_f32_16x16x32_bf16 v[180:183], v[208:211], a[48:51], v[180:183]
    v_cvt_scalef32_pk_bf16_fp4 v198, v93, s75 op_sel:[0,1,0]
    v_cvt_scalef32_pk_bf16_fp4 v199, v93, s75 op_sel:[1,1,0]
    v_mfma_f32_16x16x32_bf16 v[184:187], v[208:211], a[52:55], v[184:187]
    v_cvt_pk_bf16_f32 v227, v135, v151
    v_cvt_scalef32_pk_bf16_fp4 v200, v97, s75 op_sel:[0,0,0]
    v_mfma_f32_16x16x32_bf16 v[188:191], v[208:211], a[56:59], v[188:191]
    buffer_load_dwordx4 v[64:67], v244, s[40:43], s65 offen offset:3072 sc1
    v_mfma_f32_16x16x32_bf16 v[192:195], v[208:211], a[60:63], v[192:195]
    ds_write_b128 v251, v[224:227] offset:0
    v_mfma_f32_16x16x32_bf16 v[164:167], v[196:199], a[64:67], v[164:167]
    v_cvt_scalef32_pk_bf16_fp4 v201, v97, s75 op_sel:[1,0,0]
    v_cvt_scalef32_pk_bf16_fp4 v202, v97, s75 op_sel:[0,1,0]
    v_mfma_f32_16x16x32_bf16 v[168:171], v[196:199], a[68:71], v[168:171]
    v_cvt_scalef32_pk_bf16_fp4 v203, v97, s75 op_sel:[1,1,0]
    v_mul_f32 v136, v136, v216
    v_mfma_f32_16x16x32_bf16 v[172:175], v[196:199], a[72:75], v[172:175]
    buffer_load_dwordx4 v[68:71], v244, s[40:43], s66 offen sc1
    v_mfma_f32_16x16x32_bf16 v[176:179], v[196:199], a[76:79], v[176:179]
    v_mul_f32 v152, v152, v220
    v_cvt_scalef32_pk_bf16_fp4 v204, v94, s75 op_sel:[0,0,0]
    v_mfma_f32_16x16x32_bf16 v[180:183], v[200:203], a[64:67], v[180:183]
    v_cvt_scalef32_pk_bf16_fp4 v205, v94, s75 op_sel:[1,0,0]
    v_cvt_scalef32_pk_bf16_fp4 v206, v94, s75 op_sel:[0,1,0]
    v_mfma_f32_16x16x32_bf16 v[184:187], v[200:203], a[68:71], v[184:187]
    v_cvt_scalef32_pk_bf16_fp4 v207, v94, s75 op_sel:[1,1,0]
    v_mul_f32 v137, v137, v217
    v_mfma_f32_16x16x32_bf16 v[188:191], v[200:203], a[72:75], v[188:191]
    buffer_load_dwordx4 v[72:75], v244, s[40:43], s66 offen offset:1024 sc1
    v_mfma_f32_16x16x32_bf16 v[192:195], v[200:203], a[76:79], v[192:195]
    v_mul_f32 v153, v153, v221
    v_cvt_scalef32_pk_bf16_fp4 v208, v98, s75 op_sel:[0,0,0]
    v_mfma_f32_16x16x32_bf16 v[164:167], v[204:207], a[80:83], v[164:167]
    v_cvt_scalef32_pk_bf16_fp4 v209, v98, s75 op_sel:[1,0,0]
    v_cvt_scalef32_pk_bf16_fp4 v210, v98, s75 op_sel:[0,1,0]
    v_mfma_f32_16x16x32_bf16 v[168:171], v[204:207], a[84:87], v[168:171]
    v_cvt_scalef32_pk_bf16_fp4 v211, v98, s75 op_sel:[1,1,0]
    v_mul_f32 v138, v138, v218
    v_mfma_f32_16x16x32_bf16 v[172:175], v[204:207], a[88:91], v[172:175]
    buffer_load_dwordx4 v[76:79], v244, s[40:43], s66 offen offset:2048 sc1
    v_mfma_f32_16x16x32_bf16 v[176:179], v[204:207], a[92:95], v[176:179]
    v_mul_f32 v154, v154, v222
    v_cvt_scalef32_pk_bf16_fp4 v196, v100, s75 op_sel:[0,0,0]
    v_mfma_f32_16x16x32_bf16 v[180:183], v[208:211], a[80:83], v[180:183]
    v_cvt_scalef32_pk_bf16_fp4 v197, v100, s75 op_sel:[1,0,0]
    v_cvt_scalef32_pk_bf16_fp4 v198, v100, s75 op_sel:[0,1,0]
    v_mfma_f32_16x16x32_bf16 v[184:187], v[208:211], a[84:87], v[184:187]
    v_cvt_scalef32_pk_bf16_fp4 v199, v100, s75 op_sel:[1,1,0]
    v_mul_f32 v139, v139, v219
    v_mfma_f32_16x16x32_bf16 v[188:191], v[208:211], a[88:91], v[188:191]
    buffer_load_dwordx4 v[80:83], v244, s[40:43], s66 offen offset:3072 sc1
    v_mfma_f32_16x16x32_bf16 v[192:195], v[208:211], a[92:95], v[192:195]
    v_mul_f32 v155, v155, v223
    v_cvt_scalef32_pk_bf16_fp4 v200, v104, s75 op_sel:[0,0,0]
    v_mfma_f32_16x16x32_bf16 v[164:167], v[196:199], a[96:99], v[164:167]
    v_cvt_scalef32_pk_bf16_fp4 v201, v104, s75 op_sel:[1,0,0]
    s_add_u32 s51, s67, 64
    v_mfma_f32_16x16x32_bf16 v[168:171], v[196:199], a[100:103], v[168:171]
    v_cvt_scalef32_pk_bf16_fp4 v202, v104, s75 op_sel:[0,1,0]
    v_cvt_scalef32_pk_bf16_fp4 v203, v104, s75 op_sel:[1,1,0]
    v_mfma_f32_16x16x32_bf16 v[172:175], v[196:199], a[104:107], v[172:175]
    v_cvt_pk_bf16_f32 v228, v136, v152
    v_cvt_pk_bf16_f32 v229, v137, v153
    v_mfma_f32_16x16x32_bf16 v[176:179], v[196:199], a[108:111], v[176:179]
    v_cvt_scalef32_pk_bf16_fp4 v204, v101, s75 op_sel:[0,0,0]
    v_cvt_scalef32_pk_bf16_fp4 v205, v101, s75 op_sel:[1,0,0]
    v_mfma_f32_16x16x32_bf16 v[180:183], v[200:203], a[96:99], v[180:183]
    buffer_load_dwordx4 v[212:215], v246, s[28:31], s51 offen
    v_mfma_f32_16x16x32_bf16 v[184:187], v[200:203], a[100:103], v[184:187]
    v_cvt_scalef32_pk_bf16_fp4 v206, v101, s75 op_sel:[0,1,0]
    v_cvt_scalef32_pk_bf16_fp4 v207, v101, s75 op_sel:[1,1,0]
    v_mfma_f32_16x16x32_bf16 v[188:191], v[200:203], a[104:107], v[188:191]
    v_cvt_pk_bf16_f32 v230, v138, v154
    v_cvt_pk_bf16_f32 v231, v139, v155
    v_mfma_f32_16x16x32_bf16 v[192:195], v[200:203], a[108:111], v[192:195]
    v_cvt_scalef32_pk_bf16_fp4 v208, v105, s75 op_sel:[0,0,0]
    v_cvt_scalef32_pk_bf16_fp4 v209, v105, s75 op_sel:[1,0,0]
    v_mfma_f32_16x16x32_bf16 v[164:167], v[204:207], a[112:115], v[164:167]
    v_cvt_scalef32_pk_bf16_fp4 v210, v105, s75 op_sel:[0,1,0]
    v_cvt_scalef32_pk_bf16_fp4 v211, v105, s75 op_sel:[1,1,0]
    v_mfma_f32_16x16x32_bf16 v[168:171], v[204:207], a[116:119], v[168:171]
    ds_write_b128 v251, v[228:231] offset:2048
    v_mfma_f32_16x16x32_bf16 v[172:175], v[204:207], a[120:123], v[172:175]
    v_cvt_scalef32_pk_bf16_fp4 v196, v102, s75 op_sel:[0,0,0]
    v_cvt_scalef32_pk_bf16_fp4 v197, v102, s75 op_sel:[1,0,0]
    v_mfma_f32_16x16x32_bf16 v[176:179], v[204:207], a[124:127], v[176:179]
    v_mul_f32 v140, v140, v216
    v_cvt_scalef32_pk_bf16_fp4 v198, v102, s75 op_sel:[0,1,0]
    v_mfma_f32_16x16x32_bf16 v[180:183], v[208:211], a[112:115], v[180:183]
    v_cvt_scalef32_pk_bf16_fp4 v199, v102, s75 op_sel:[1,1,0]
    v_mul_f32 v156, v156, v220
    v_mfma_f32_16x16x32_bf16 v[184:187], v[208:211], a[116:119], v[184:187]
    v_cvt_scalef32_pk_bf16_fp4 v200, v106, s75 op_sel:[0,0,0]
    v_cvt_scalef32_pk_bf16_fp4 v201, v106, s75 op_sel:[1,0,0]
    v_mfma_f32_16x16x32_bf16 v[188:191], v[208:211], a[120:123], v[188:191]
    v_mul_f32 v141, v141, v217
    v_cvt_scalef32_pk_bf16_fp4 v202, v106, s75 op_sel:[0,1,0]
    v_mfma_f32_16x16x32_bf16 v[192:195], v[208:211], a[124:127], v[192:195]
    v_cvt_scalef32_pk_bf16_fp4 v203, v106, s75 op_sel:[1,1,0]
    v_mul_f32 v157, v157, v221
    v_mfma_f32_16x16x32_bf16 v[164:167], v[196:199], a[128:131], v[164:167]
    v_cvt_scalef32_pk_bf16_fp4 v204, v108, s75 op_sel:[0,0,0]
    v_cvt_scalef32_pk_bf16_fp4 v205, v108, s75 op_sel:[1,0,0]
    v_mfma_f32_16x16x32_bf16 v[168:171], v[196:199], a[132:135], v[168:171]
    v_mul_f32 v142, v142, v218
    v_cvt_scalef32_pk_bf16_fp4 v206, v108, s75 op_sel:[0,1,0]
    v_mfma_f32_16x16x32_bf16 v[172:175], v[196:199], a[136:139], v[172:175]
    v_cvt_scalef32_pk_bf16_fp4 v207, v108, s75 op_sel:[1,1,0]
    v_mul_f32 v158, v158, v222
    v_mfma_f32_16x16x32_bf16 v[176:179], v[196:199], a[140:143], v[176:179]
    v_cvt_scalef32_pk_bf16_fp4 v208, v112, s75 op_sel:[0,0,0]
    v_cvt_scalef32_pk_bf16_fp4 v209, v112, s75 op_sel:[1,0,0]
    v_mfma_f32_16x16x32_bf16 v[180:183], v[200:203], a[128:131], v[180:183]
    v_mul_f32 v143, v143, v219
    v_cvt_scalef32_pk_bf16_fp4 v210, v112, s75 op_sel:[0,1,0]
    v_mfma_f32_16x16x32_bf16 v[184:187], v[200:203], a[132:135], v[184:187]
    v_cvt_scalef32_pk_bf16_fp4 v211, v112, s75 op_sel:[1,1,0]
    v_mul_f32 v159, v159, v223
    v_mfma_f32_16x16x32_bf16 v[188:191], v[200:203], a[136:139], v[188:191]
    v_cvt_scalef32_pk_bf16_fp4 v196, v109, s75 op_sel:[0,0,0]
    v_cvt_scalef32_pk_bf16_fp4 v197, v109, s75 op_sel:[1,0,0]
    v_mfma_f32_16x16x32_bf16 v[192:195], v[200:203], a[140:143], v[192:195]
    v_cvt_pk_bf16_f32 v224, v140, v156
    v_cvt_scalef32_pk_bf16_fp4 v198, v109, s75 op_sel:[0,1,0]
    v_mfma_f32_16x16x32_bf16 v[164:167], v[204:207], a[144:147], v[164:167]
    v_cvt_scalef32_pk_bf16_fp4 v199, v109, s75 op_sel:[1,1,0]
    v_cvt_pk_bf16_f32 v225, v141, v157
    v_mfma_f32_16x16x32_bf16 v[168:171], v[204:207], a[148:151], v[168:171]
    v_cvt_scalef32_pk_bf16_fp4 v200, v113, s75 op_sel:[0,0,0]
    v_cvt_scalef32_pk_bf16_fp4 v201, v113, s75 op_sel:[1,0,0]
    v_mfma_f32_16x16x32_bf16 v[172:175], v[204:207], a[152:155], v[172:175]
    v_cvt_pk_bf16_f32 v226, v142, v158
    v_cvt_scalef32_pk_bf16_fp4 v202, v113, s75 op_sel:[0,1,0]
    v_mfma_f32_16x16x32_bf16 v[176:179], v[204:207], a[156:159], v[176:179]
    v_cvt_scalef32_pk_bf16_fp4 v203, v113, s75 op_sel:[1,1,0]
    v_cvt_pk_bf16_f32 v227, v143, v159
    v_mfma_f32_16x16x32_bf16 v[180:183], v[208:211], a[144:147], v[180:183]
    v_cvt_scalef32_pk_bf16_fp4 v204, v110, s75 op_sel:[0,0,0]
    v_cvt_scalef32_pk_bf16_fp4 v205, v110, s75 op_sel:[1,0,0]
    v_mfma_f32_16x16x32_bf16 v[184:187], v[208:211], a[148:151], v[184:187]
    ds_write_b128 v251, v[224:227] offset:4096
    v_mfma_f32_16x16x32_bf16 v[188:191], v[208:211], a[152:155], v[188:191]
    v_cvt_scalef32_pk_bf16_fp4 v206, v110, s75 op_sel:[0,1,0]
    v_cvt_scalef32_pk_bf16_fp4 v207, v110, s75 op_sel:[1,1,0]
    v_mfma_f32_16x16x32_bf16 v[192:195], v[208:211], a[156:159], v[192:195]
    v_mul_f32 v144, v144, v216
    v_cvt_scalef32_pk_bf16_fp4 v208, v114, s75 op_sel:[0,0,0]
    v_mfma_f32_16x16x32_bf16 v[164:167], v[196:199], a[160:163], v[164:167]
    v_cvt_scalef32_pk_bf16_fp4 v209, v114, s75 op_sel:[1,0,0]
    v_mul_f32 v160, v160, v220
    v_mfma_f32_16x16x32_bf16 v[168:171], v[196:199], a[164:167], v[168:171]
    v_cvt_scalef32_pk_bf16_fp4 v210, v114, s75 op_sel:[0,1,0]
    v_cvt_scalef32_pk_bf16_fp4 v211, v114, s75 op_sel:[1,1,0]
    v_mfma_f32_16x16x32_bf16 v[172:175], v[196:199], a[168:171], v[172:175]
    v_mul_f32 v145, v145, v217
    v_mul_f32 v161, v161, v221
    v_mfma_f32_16x16x32_bf16 v[176:179], v[196:199], a[172:175], v[176:179]
    v_cvt_scalef32_pk_bf16_fp4 v196, v116, s75 op_sel:[0,0,0]
    v_cvt_scalef32_pk_bf16_fp4 v197, v116, s75 op_sel:[1,0,0]
    v_mfma_f32_16x16x32_bf16 v[180:183], v[200:203], a[160:163], v[180:183]
    v_cvt_scalef32_pk_bf16_fp4 v198, v116, s75 op_sel:[0,1,0]
    v_cvt_scalef32_pk_bf16_fp4 v199, v116, s75 op_sel:[1,1,0]
    v_mfma_f32_16x16x32_bf16 v[184:187], v[200:203], a[164:167], v[184:187]
    v_mul_f32 v146, v146, v218
    v_mul_f32 v162, v162, v222
    v_mfma_f32_16x16x32_bf16 v[188:191], v[200:203], a[168:171], v[188:191]
    v_mul_f32 v147, v147, v219
    v_mul_f32 v163, v163, v223
    v_mfma_f32_16x16x32_bf16 v[192:195], v[200:203], a[172:175], v[192:195]
    v_cvt_scalef32_pk_bf16_fp4 v200, v120, s75 op_sel:[0,0,0]
    v_cvt_scalef32_pk_bf16_fp4 v201, v120, s75 op_sel:[1,0,0]
    v_mfma_f32_16x16x32_bf16 v[164:167], v[204:207], a[176:179], v[164:167]
    v_cvt_scalef32_pk_bf16_fp4 v202, v120, s75 op_sel:[0,1,0]
    v_cvt_scalef32_pk_bf16_fp4 v203, v120, s75 op_sel:[1,1,0]
    v_mfma_f32_16x16x32_bf16 v[168:171], v[204:207], a[180:183], v[168:171]
    v_cvt_pk_bf16_f32 v228, v144, v160
    v_cvt_pk_bf16_f32 v229, v145, v161
    v_mfma_f32_16x16x32_bf16 v[172:175], v[204:207], a[184:187], v[172:175]
    v_cvt_pk_bf16_f32 v230, v146, v162
    v_cvt_pk_bf16_f32 v231, v147, v163
    v_mfma_f32_16x16x32_bf16 v[176:179], v[204:207], a[188:191], v[176:179]
    v_cvt_scalef32_pk_bf16_fp4 v204, v117, s75 op_sel:[0,0,0]
    v_cvt_scalef32_pk_bf16_fp4 v205, v117, s75 op_sel:[1,0,0]
    v_mfma_f32_16x16x32_bf16 v[180:183], v[208:211], a[176:179], v[180:183]
    v_cvt_scalef32_pk_bf16_fp4 v206, v117, s75 op_sel:[0,1,0]
    v_cvt_scalef32_pk_bf16_fp4 v207, v117, s75 op_sel:[1,1,0]
    v_mfma_f32_16x16x32_bf16 v[184:187], v[208:211], a[180:183], v[184:187]
    ds_write_b128 v251, v[228:231] offset:6144
    v_mfma_f32_16x16x32_bf16 v[188:191], v[208:211], a[184:187], v[188:191]
    v_mfma_f32_16x16x32_bf16 v[192:195], v[208:211], a[188:191], v[192:195]
    v_cvt_scalef32_pk_bf16_fp4 v208, v121, s75 op_sel:[0,0,0]
    v_cvt_scalef32_pk_bf16_fp4 v209, v121, s75 op_sel:[1,0,0]
    v_mfma_f32_16x16x32_bf16 v[164:167], v[196:199], a[192:195], v[164:167]
    v_cvt_scalef32_pk_bf16_fp4 v210, v121, s75 op_sel:[0,1,0]
    v_cvt_scalef32_pk_bf16_fp4 v211, v121, s75 op_sel:[1,1,0]
    v_mfma_f32_16x16x32_bf16 v[168:171], v[196:199], a[196:199], v[168:171]
    v_mfma_f32_16x16x32_bf16 v[172:175], v[196:199], a[200:203], v[172:175]
    v_mfma_f32_16x16x32_bf16 v[176:179], v[196:199], a[204:207], v[176:179]
    v_cvt_scalef32_pk_bf16_fp4 v196, v118, s75 op_sel:[0,0,0]
    v_cvt_scalef32_pk_bf16_fp4 v197, v118, s75 op_sel:[1,0,0]
    v_mfma_f32_16x16x32_bf16 v[180:183], v[200:203], a[192:195], v[180:183]
    v_cvt_scalef32_pk_bf16_fp4 v198, v118, s75 op_sel:[0,1,0]
    v_cvt_scalef32_pk_bf16_fp4 v199, v118, s75 op_sel:[1,1,0]
    v_mfma_f32_16x16x32_bf16 v[184:187], v[200:203], a[196:199], v[184:187]
    v_mfma_f32_16x16x32_bf16 v[188:191], v[200:203], a[200:203], v[188:191]
    v_mfma_f32_16x16x32_bf16 v[192:195], v[200:203], a[204:207], v[192:195]
    v_cvt_scalef32_pk_bf16_fp4 v200, v122, s75 op_sel:[0,0,0]
    v_cvt_scalef32_pk_bf16_fp4 v201, v122, s75 op_sel:[1,0,0]
    v_mfma_f32_16x16x32_bf16 v[164:167], v[204:207], a[208:211], v[164:167]
    v_cvt_scalef32_pk_bf16_fp4 v202, v122, s75 op_sel:[0,1,0]
    v_cvt_scalef32_pk_bf16_fp4 v203, v122, s75 op_sel:[1,1,0]
    v_mfma_f32_16x16x32_bf16 v[168:171], v[204:207], a[212:215], v[168:171]
    v_mfma_f32_16x16x32_bf16 v[172:175], v[204:207], a[216:219], v[172:175]
    v_mfma_f32_16x16x32_bf16 v[176:179], v[204:207], a[220:223], v[176:179]
    v_cvt_scalef32_pk_bf16_fp4 v204, v124, s75 op_sel:[0,0,0]
    v_cvt_scalef32_pk_bf16_fp4 v205, v124, s75 op_sel:[1,0,0]
    v_mfma_f32_16x16x32_bf16 v[180:183], v[208:211], a[208:211], v[180:183]
    v_cvt_scalef32_pk_bf16_fp4 v206, v124, s75 op_sel:[0,1,0]
    v_cvt_scalef32_pk_bf16_fp4 v207, v124, s75 op_sel:[1,1,0]
    v_mfma_f32_16x16x32_bf16 v[184:187], v[208:211], a[212:215], v[184:187]
    v_mfma_f32_16x16x32_bf16 v[188:191], v[208:211], a[216:219], v[188:191]
    v_mfma_f32_16x16x32_bf16 v[192:195], v[208:211], a[220:223], v[192:195]
    v_cvt_scalef32_pk_bf16_fp4 v208, v128, s75 op_sel:[0,0,0]
    v_cvt_scalef32_pk_bf16_fp4 v209, v128, s75 op_sel:[1,0,0]
    v_mfma_f32_16x16x32_bf16 v[164:167], v[196:199], a[224:227], v[164:167]
    s_waitcnt vmcnt(0)
    v_xad_u32 v249, v39, s53, 0
    v_mfma_f32_16x16x32_bf16 v[168:171], v[196:199], a[228:231], v[168:171]
    v_xad_u32 v249, v43, s53, v249
    v_xad_u32 v249, v47, s53, v249
    v_mfma_f32_16x16x32_bf16 v[172:175], v[196:199], a[232:235], v[172:175]
    v_xad_u32 v249, v51, s53, v249
    v_cvt_scalef32_pk_bf16_fp4 v210, v128, s75 op_sel:[0,1,0]
    v_mfma_f32_16x16x32_bf16 v[176:179], v[196:199], a[236:239], v[176:179]
    v_cvt_scalef32_pk_bf16_fp4 v211, v128, s75 op_sel:[1,1,0]
    v_xad_u32 v249, v55, s53, v249
    v_mfma_f32_16x16x32_bf16 v[180:183], v[200:203], a[224:227], v[180:183]
    v_cvt_scalef32_pk_bf16_fp4 v196, v125, s75 op_sel:[0,0,0]
    v_cvt_scalef32_pk_bf16_fp4 v197, v125, s75 op_sel:[1,0,0]
    v_mfma_f32_16x16x32_bf16 v[184:187], v[200:203], a[228:231], v[184:187]
    v_xad_u32 v249, v59, s53, v249
    v_cvt_scalef32_pk_bf16_fp4 v198, v125, s75 op_sel:[0,1,0]
    v_mfma_f32_16x16x32_bf16 v[188:191], v[200:203], a[232:235], v[188:191]
    v_cvt_scalef32_pk_bf16_fp4 v199, v125, s75 op_sel:[1,1,0]
    v_xad_u32 v249, v63, s53, v249
    v_mfma_f32_16x16x32_bf16 v[192:195], v[200:203], a[236:239], v[192:195]
    v_cvt_scalef32_pk_bf16_fp4 v200, v129, s75 op_sel:[0,0,0]
    v_cvt_scalef32_pk_bf16_fp4 v201, v129, s75 op_sel:[1,0,0]
    v_mfma_f32_16x16x32_bf16 v[164:167], v[204:207], a[240:243], v[164:167]
    v_xad_u32 v249, v67, s53, v249
    v_cvt_scalef32_pk_bf16_fp4 v202, v129, s75 op_sel:[0,1,0]
    v_mfma_f32_16x16x32_bf16 v[168:171], v[204:207], a[244:247], v[168:171]
    v_cvt_scalef32_pk_bf16_fp4 v203, v129, s75 op_sel:[1,1,0]
    v_xad_u32 v249, v71, s53, v249
    v_mfma_f32_16x16x32_bf16 v[172:175], v[204:207], a[248:251], v[172:175]
    v_xad_u32 v249, v75, s53, v249
    v_xad_u32 v249, v79, s53, v249
    v_mfma_f32_16x16x32_bf16 v[176:179], v[204:207], a[252:255], v[176:179]
    v_xad_u32 v249, v83, s53, v249
    v_cvt_scalef32_pk_bf16_fp4 v204, v126, s75 op_sel:[0,0,0]
    v_mfma_f32_16x16x32_bf16 v[180:183], v[208:211], a[240:243], v[180:183]
    v_cvt_scalef32_pk_bf16_fp4 v205, v126, s75 op_sel:[1,0,0]
    v_cmp_ne_u32 vcc, 0, v249
    v_mfma_f32_16x16x32_bf16 v[184:187], v[208:211], a[244:247], v[184:187]
    v_cvt_scalef32_pk_bf16_fp4 v206, v126, s75 op_sel:[0,1,0]
    v_cvt_scalef32_pk_bf16_fp4 v207, v126, s75 op_sel:[1,1,0]
    v_mfma_f32_16x16x32_bf16 v[188:191], v[208:211], a[248:251], v[188:191]
    s_cbranch_vccnz K_retry2
K_back2:
    v_mfma_f32_16x16x32_bf16 v[192:195], v[208:211], a[252:255], v[192:195]
    v_cvt_scalef32_pk_bf16_fp4 v208, v130, s75 op_sel:[0,0,0]
    v_cvt_scalef32_pk_bf16_fp4 v209, v130, s75 op_sel:[1,0,0]
    v_mfma_f32_16x16x32_bf16 v[164:167], v[196:199], v[4:7], v[164:167]
    v_cvt_scalef32_pk_bf16_fp4 v210, v130, s75 op_sel:[0,1,0]
    v_cvt_scalef32_pk_bf16_fp4 v211, v130, s75 op_sel:[1,1,0]
    v_mfma_f32_16x16x32_bf16 v[168:171], v[196:199], v[8:11], v[168:171]
    v_mfma_f32_16x16x32_bf16 v[172:175], v[196:199], v[12:15], v[172:175]
    v_mfma_f32_16x16x32_bf16 v[176:179], v[196:199], v[16:19], v[176:179]
    v_cvt_scalef32_pk_bf16_fp4 v196, v36, s75 op_sel:[0,0,0]
    v_cvt_scalef32_pk_bf16_fp4 v197, v36, s75 op_sel:[1,0,0]
    v_mfma_f32_16x16x32_bf16 v[180:183], v[200:203], v[4:7], v[180:183]
    v_cvt_scalef32_pk_bf16_fp4 v198, v36, s75 op_sel:[0,1,0]
    v_cvt_scalef32_pk_bf16_fp4 v199, v36, s75 op_sel:[1,1,0]
    v_mfma_f32_16x16x32_bf16 v[184:187], v[200:203], v[8:11], v[184:187]
    v_mfma_f32_16x16x32_bf16 v[188:191], v[200:203], v[12:15], v[188:191]
    v_mfma_f32_16x16x32_bf16 v[192:195], v[200:203], v[16:19], v[192:195]
    v_cvt_scalef32_pk_bf16_fp4 v200, v40, s75 op_sel:[0,0,0]
    v_cvt_scalef32_pk_bf16_fp4 v201, v40, s75 op_sel:[1,0,0]
    v_mfma_f32_16x16x32_bf16 v[164:167], v[204:207], v[20:23], v[164:167]
    v_cvt_scalef32_pk_bf16_fp4 v202, v40, s75 op_sel:[0,1,0]
    v_cvt_scalef32_pk_bf16_fp4 v203, v40, s75 op_sel:[1,1,0]
    v_mfma_f32_16x16x32_bf16 v[168:171], v[204:207], v[24:27], v[168:171]
    v_mfma_f32_16x16x32_bf16 v[172:175], v[204:207], v[28:31], v[172:175]
    v_mfma_f32_16x16x32_bf16 v[176:179], v[204:207], v[32:35], v[176:179]
    v_cvt_scalef32_pk_bf16_fp4 v204, v37, s75 op_sel:[0,0,0]
    v_cvt_scalef32_pk_bf16_fp4 v205, v37, s75 op_sel:[1,0,0]
    v_mfma_f32_16x16x32_bf16 v[180:183], v[208:211], v[20:23], v[180:183]
    v_cvt_scalef32_pk_bf16_fp4 v206, v37, s75 op_sel:[0,1,0]
    v_cvt_scalef32_pk_bf16_fp4 v207, v37, s75 op_sel:[1,1,0]
    v_mfma_f32_16x16x32_bf16 v[184:187], v[208:211], v[24:27], v[184:187]
    v_mfma_f32_16x16x32_bf16 v[188:191], v[208:211], v[28:31], v[188:191]
    v_mfma_f32_16x16x32_bf16 v[192:195], v[208:211], v[32:35], v[192:195]
    v_cvt_scalef32_pk_bf16_fp4 v208, v41, s75 op_sel:[0,0,0]
    v_cvt_scalef32_pk_bf16_fp4 v209, v41, s75 op_sel:[1,0,0]
    v_mfma_f32_16x16x32_bf16 v[132:135], v[196:199], a[0:3], 0
    s_add_u32 s64, s62, 110592
    s_add_u32 s65, s62, 114688
    v_mfma_f32_16x16x32_bf16 v[136:139], v[196:199], a[4:7], 0
    s_add_u32 s66, s62, 118784
    v_cvt_scalef32_pk_bf16_fp4 v210, v41, s75 op_sel:[0,1,0]
    v_mfma_f32_16x16x32_bf16 v[140:143], v[196:199], a[8:11], 0
    buffer_load_dwordx4 v[84:87], v244, s[40:43], s64 offen sc1
    v_mfma_f32_16x16x32_bf16 v[144:147], v[196:199], a[12:15], 0
    v_cvt_scalef32_pk_bf16_fp4 v211, v41, s75 op_sel:[1,1,0]
    v_lshlrev_b32 v216, 16, v212
    v_mfma_f32_16x16x32_bf16 v[148:151], v[200:203], a[0:3], 0
    buffer_load_dwordx4 v[88:91], v244, s[40:43], s64 offen offset:1024 sc1
    v_mfma_f32_16x16x32_bf16 v[152:155], v[200:203], a[4:7], 0
    v_and_b32 v220, 0xffff0000, v212
    v_lshlrev_b32 v217, 16, v213
    v_mfma_f32_16x16x32_bf16 v[156:159], v[200:203], a[8:11], 0
    v_and_b32 v221, 0xffff0000, v213
    v_lshlrev_b32 v218, 16, v214
    v_mfma_f32_16x16x32_bf16 v[160:163], v[200:203], a[12:15], 0
    v_and_b32 v222, 0xffff0000, v214
    v_lshlrev_b32 v219, 16, v215
    v_mfma_f32_16x16x32_bf16 v[132:135], v[204:207], a[16:19], v[132:135]
    v_and_b32 v223, 0xffff0000, v215
    v_mul_f32 v164, v164, v216
    v_mfma_f32_16x16x32_bf16 v[136:139], v[204:207], a[20:23], v[136:139]
    v_mul_f32 v180, v180, v220
    v_mul_f32 v165, v165, v217
    v_mfma_f32_16x16x32_bf16 v[140:143], v[204:207], a[24:27], v[140:143]
    v_cvt_scalef32_pk_bf16_fp4 v196, v38, s75 op_sel:[0,0,0]
    v_cvt_scalef32_pk_bf16_fp4 v197, v38, s75 op_sel:[1,0,0]
    v_mfma_f32_16x16x32_bf16 v[144:147], v[204:207], a[28:31], v[144:147]
    v_cvt_scalef32_pk_bf16_fp4 v198, v38, s75 op_sel:[0,1,0]
    v_cvt_scalef32_pk_bf16_fp4 v199, v38, s75 op_sel:[1,1,0]
    v_mfma_f32_16x16x32_bf16 v[148:151], v[208:211], a[16:19], v[148:151]
    buffer_load_dwordx4 v[92:95], v244, s[40:43], s64 offen offset:2048 sc1
    v_mfma_f32_16x16x32_bf16 v[152:155], v[208:211], a[20:23], v[152:155]
    v_mul_f32 v181, v181, v221
    v_mul_f32 v166, v166, v218
    v_mfma_f32_16x16x32_bf16 v[156:159], v[208:211], a[24:27], v[156:159]
    v_cvt_scalef32_pk_bf16_fp4 v200, v42, s75 op_sel:[0,0,0]
    v_cvt_scalef32_pk_bf16_fp4 v201, v42, s75 op_sel:[1,0,0]
    v_mfma_f32_16x16x32_bf16 v[160:163], v[208:211], a[28:31], v[160:163]
    v_cvt_scalef32_pk_bf16_fp4 v202, v42, s75 op_sel:[0,1,0]
    v_cvt_scalef32_pk_bf16_fp4 v203, v42, s75 op_sel:[1,1,0]
    v_mfma_f32_16x16x32_bf16 v[132:135], v[196:199], a[32:35], v[132:135]
    buffer_load_dwordx4 v[96:99], v244, s[40:43], s64 offen offset:3072 sc1
    v_mfma_f32_16x16x32_bf16 v[136:139], v[196:199], a[36:39], v[136:139]
    v_mul_f32 v182, v182, v222
    v_mul_f32 v167, v167, v219
    v_mfma_f32_16x16x32_bf16 v[140:143], v[196:199], a[40:43], v[140:143]
    v_cvt_scalef32_pk_bf16_fp4 v204, v44, s75 op_sel:[0,0,0]
    v_cvt_scalef32_pk_bf16_fp4 v205, v44, s75 op_sel:[1,0,0]
    v_mfma_f32_16x16x32_bf16 v[144:147], v[196:199], a[44:47], v[144:147]
    buffer_load_dwordx4 v[100:103], v244, s[40:43], s65 offen sc1
    v_mfma_f32_16x16x32_bf16 v[148:151], v[200:203], a[32:35], v[148:151]
    v_cvt_scalef32_pk_bf16_fp4 v206, v44, s75 op_sel:[0,1,0]
    v_cvt_scalef32_pk_bf16_fp4 v207, v44, s75 op_sel:[1,1,0]
    v_mfma_f32_16x16x32_bf16 v[152:155], v[200:203], a[36:39], v[152:155]
    v_mul_f32 v183, v183, v223
    v_cvt_pk_bf16_f32 v224, v164, v180
    v_mfma_f32_16x16x32_bf16 v[156:159], v[200:203], a[40:43], v[156:159]
    v_cvt_scalef32_pk_bf16_fp4 v208, v48, s75 op_sel:[0,0,0]
    v_cvt_scalef32_pk_bf16_fp4 v209, v48, s75 op_sel:[1,0,0]
    v_mfma_f32_16x16x32_bf16 v[160:163], v[200:203], a[44:47], v[160:163]
    buffer_load_dwordx4 v[104:107], v244, s[40:43], s65 offen offset:1024 sc1
    v_mfma_f32_16x16x32_bf16 v[132:135], v[204:207], a[48:51], v[132:135]
    v_cvt_scalef32_pk_bf16_fp4 v210, v48, s75 op_sel:[0,1,0]
    v_cvt_scalef32_pk_bf16_fp4 v211, v48, s75 op_sel:[1,1,0]
    v_mfma_f32_16x16x32_bf16 v[136:139], v[204:207], a[52:55], v[136:139]
    v_cvt_pk_bf16_f32 v225, v165, v181
    v_cvt_pk_bf16_f32 v226, v166, v182
    v_mfma_f32_16x16x32_bf16 v[140:143], v[204:207], a[56:59], v[140:143]
    v_cvt_scalef32_pk_bf16_fp4 v196, v45, s75 op_sel:[0,0,0]
    v_cvt_scalef32_pk_bf16_fp4 v197, v45, s75 op_sel:[1,0,0]
    v_mfma_f32_16x16x32_bf16 v[144:147], v[204:207], a[60:63], v[144:147]
    buffer_load_dwordx4 v[108:111], v244, s[40:43], s65 offen offset:2048 sc1
    v_mfma_f32_16x16x32_bf16 v[148:151], v[208:211], a[48:51], v[148:151]
    v_cvt_scalef32_pk_bf16_fp4 v198, v45, s75 op_sel:[0,1,0]
    v_cvt_scalef32_pk_bf16_fp4 v199, v45, s75 op_sel:[1,1,0]
    v_mfma_f32_16x16x32_bf16 v[152:155], v[208:211], a[52:55], v[152:155]
    v_cvt_pk_bf16_f32 v227, v167, v183
    v_cvt_scalef32_pk_bf16_fp4 v200, v49, s75 op_sel:[0,0,0]
    v_mfma_f32_16x16x32_bf16 v[156:159], v[208:211], a[56:59], v[156:159]
    buffer_load_dwordx4 v[112:115], v244, s[40:43], s65 offen offset:3072 sc1
    v_mfma_f32_16x16x32_bf16 v[160:163], v[208:211], a[60:63], v[160:163]
    ds_write_b128 v252, v[224:227] offset:0
    v_mfma_f32_16x16x32_bf16 v[132:135], v[196:199], a[64:67], v[132:135]
    v_cvt_scalef32_pk_bf16_fp4 v201, v49, s75 op_sel:[1,0,0]
    v_cvt_scalef32_pk_bf16_fp4 v202, v49, s75 op_sel:[0,1,0]
    v_mfma_f32_16x16x32_bf16 v[136:139], v[196:199], a[68:71], v[136:139]
    v_cvt_scalef32_pk_bf16_fp4 v203, v49, s75 op_sel:[1,1,0]
    v_mul_f32 v168, v168, v216
    v_mfma_f32_16x16x32_bf16 v[140:143], v[196:199], a[72:75], v[140:143]
    buffer_load_dwordx4 v[116:119], v244, s[40:43], s66 offen sc1
    v_mfma_f32_16x16x32_bf16 v[144:147], v[196:199], a[76:79], v[144:147]
    v_mul_f32 v184, v184, v220
    v_cvt_scalef32_pk_bf16_fp4 v204, v46, s75 op_sel:[0,0,0]
    v_mfma_f32_16x16x32_bf16 v[148:151], v[200:203], a[64:67], v[148:151]
    v_cvt_scalef32_pk_bf16_fp4 v205, v46, s75 op_sel:[1,0,0]
    v_cvt_scalef32_pk_bf16_fp4 v206, v46, s75 op_sel:[0,1,0]
    v_mfma_f32_16x16x32_bf16 v[152:155], v[200:203], a[68:71], v[152:155]
    v_cvt_scalef32_pk_bf16_fp4 v207, v46, s75 op_sel:[1,1,0]
    v_mul_f32 v169, v169, v217
    v_mfma_f32_16x16x32_bf16 v[156:159], v[200:203], a[72:75], v[156:159]
    buffer_load_dwordx4 v[120:123], v244, s[40:43], s66 offen offset:1024 sc1
    v_mfma_f32_16x16x32_bf16 v[160:163], v[200:203], a[76:79], v[160:163]
    v_mul_f32 v185, v185, v221
    v_cvt_scalef32_pk_bf16_fp4 v208, v50, s75 op_sel:[0,0,0]
    v_mfma_f32_16x16x32_bf16 v[132:135], v[204:207], a[80:83], v[132:135]
    v_cvt_scalef32_pk_bf16_fp4 v209, v50, s75 op_sel:[1,0,0]
    v_cvt_scalef32_pk_bf16_fp4 v210, v50, s75 op_sel:[0,1,0]
    v_mfma_f32_16x16x32_bf16 v[136:139], v[204:207], a[84:87], v[136:139]
    v_cvt_scalef32_pk_bf16_fp4 v211, v50, s75 op_sel:[1,1,0]
    v_mul_f32 v170, v170, v218
    v_mfma_f32_16x16x32_bf16 v[140:143], v[204:207], a[88:91], v[140:143]
    buffer_load_dwordx4 v[124:127], v244, s[40:43], s66 offen offset:2048 sc1
    v_mfma_f32_16x16x32_bf16 v[144:147], v[204:207], a[92:95], v[144:147]
    v_mul_f32 v186, v186, v222
    v_cvt_scalef32_pk_bf16_fp4 v196, v52, s75 op_sel:[0,0,0]
    v_mfma_f32_16x16x32_bf16 v[148:151], v[208:211], a[80:83], v[148:151]
    v_cvt_scalef32_pk_bf16_fp4 v197, v52, s75 op_sel:[1,0,0]
    v_cvt_scalef32_pk_bf16_fp4 v198, v52, s75 op_sel:[0,1,0]
    v_mfma_f32_16x16x32_bf16 v[152:155], v[208:211], a[84:87], v[152:155]
    v_cvt_scalef32_pk_bf16_fp4 v199, v52, s75 op_sel:[1,1,0]
    v_mul_f32 v171, v171, v219
    v_mfma_f32_16x16x32_bf16 v[156:159], v[208:211], a[88:91], v[156:159]
    buffer_load_dwordx4 v[128:131], v244, s[40:43], s66 offen offset:3072 sc1
    v_mfma_f32_16x16x32_bf16 v[160:163], v[208:211], a[92:95], v[160:163]
    v_mul_f32 v187, v187, v223
    v_cvt_scalef32_pk_bf16_fp4 v200, v56, s75 op_sel:[0,0,0]
    v_mfma_f32_16x16x32_bf16 v[132:135], v[196:199], a[96:99], v[132:135]
    v_cvt_scalef32_pk_bf16_fp4 v201, v56, s75 op_sel:[1,0,0]
    s_add_u32 s51, s67, 512
    v_mfma_f32_16x16x32_bf16 v[136:139], v[196:199], a[100:103], v[136:139]
    v_cvt_scalef32_pk_bf16_fp4 v202, v56, s75 op_sel:[0,1,0]
    v_cvt_scalef32_pk_bf16_fp4 v203, v56, s75 op_sel:[1,1,0]
    v_mfma_f32_16x16x32_bf16 v[140:143], v[196:199], a[104:107], v[140:143]
    v_cvt_pk_bf16_f32 v228, v168, v184
    v_cvt_pk_bf16_f32 v229, v169, v185
    v_mfma_f32_16x16x32_bf16 v[144:147], v[196:199], a[108:111], v[144:147]
    v_cvt_scalef32_pk_bf16_fp4 v204, v53, s75 op_sel:[0,0,0]
    v_cvt_scalef32_pk_bf16_fp4 v205, v53, s75 op_sel:[1,0,0]
    v_mfma_f32_16x16x32_bf16 v[148:151], v[200:203], a[96:99], v[148:151]
    buffer_load_dwordx4 v[212:215], v246, s[28:31], s51 offen
    v_mfma_f32_16x16x32_bf16 v[152:155], v[200:203], a[100:103], v[152:155]
    v_cvt_scalef32_pk_bf16_fp4 v206, v53, s75 op_sel:[0,1,0]
    v_cvt_scalef32_pk_bf16_fp4 v207, v53, s75 op_sel:[1,1,0]
    v_mfma_f32_16x16x32_bf16 v[156:159], v[200:203], a[104:107], v[156:159]
    v_cvt_pk_bf16_f32 v230, v170, v186
    v_cvt_pk_bf16_f32 v231, v171, v187
    v_mfma_f32_16x16x32_bf16 v[160:163], v[200:203], a[108:111], v[160:163]
    v_cvt_scalef32_pk_bf16_fp4 v208, v57, s75 op_sel:[0,0,0]
    v_cvt_scalef32_pk_bf16_fp4 v209, v57, s75 op_sel:[1,0,0]
    v_mfma_f32_16x16x32_bf16 v[132:135], v[204:207], a[112:115], v[132:135]
    v_cvt_scalef32_pk_bf16_fp4 v210, v57, s75 op_sel:[0,1,0]
    v_cvt_scalef32_pk_bf16_fp4 v211, v57, s75 op_sel:[1,1,0]
    v_mfma_f32_16x16x32_bf16 v[136:139], v[204:207], a[116:119], v[136:139]
    ds_write_b128 v252, v[228:231] offset:2048
    v_mfma_f32_16x16x32_bf16 v[140:143], v[204:207], a[120:123], v[140:143]
    v_cvt_scalef32_pk_bf16_fp4 v196, v54, s75 op_sel:[0,0,0]
    v_cvt_scalef32_pk_bf16_fp4 v197, v54, s75 op_sel:[1,0,0]
    v_mfma_f32_16x16x32_bf16 v[144:147], v[204:207], a[124:127], v[144:147]
    v_mul_f32 v172, v172, v216
    v_cvt_scalef32_pk_bf16_fp4 v198, v54, s75 op_sel:[0,1,0]
    v_mfma_f32_16x16x32_bf16 v[148:151], v[208:211], a[112:115], v[148:151]
    v_cvt_scalef32_pk_bf16_fp4 v199, v54, s75 op_sel:[1,1,0]
    v_mul_f32 v188, v188, v220
    v_mfma_f32_16x16x32_bf16 v[152:155], v[208:211], a[116:119], v[152:155]
    v_cvt_scalef32_pk_bf16_fp4 v200, v58, s75 op_sel:[0,0,0]
    v_cvt_scalef32_pk_bf16_fp4 v201, v58, s75 op_sel:[1,0,0]
    v_mfma_f32_16x16x32_bf16 v[156:159], v[208:211], a[120:123], v[156:159]
    v_mul_f32 v173, v173, v217
    v_cvt_scalef32_pk_bf16_fp4 v202, v58, s75 op_sel:[0,1,0]
    v_mfma_f32_16x16x32_bf16 v[160:163], v[208:211], a[124:127], v[160:163]
    v_cvt_scalef32_pk_bf16_fp4 v203, v58, s75 op_sel:[1,1,0]
    v_mul_f32 v189, v189, v221
    v_mfma_f32_16x16x32_bf16 v[132:135], v[196:199], a[128:131], v[132:135]
    v_cvt_scalef32_pk_bf16_fp4 v204, v60, s75 op_sel:[0,0,0]
    v_cvt_scalef32_pk_bf16_fp4 v205, v60, s75 op_sel:[1,0,0]
    v_mfma_f32_16x16x32_bf16 v[136:139], v[196:199], a[132:135], v[136:139]
    v_mul_f32 v174, v174, v218
    v_cvt_scalef32_pk_bf16_fp4 v206, v60, s75 op_sel:[0,1,0]
    v_mfma_f32_16x16x32_bf16 v[140:143], v[196:199], a[136:139], v[140:143]
    v_cvt_scalef32_pk_bf16_fp4 v207, v60, s75 op_sel:[1,1,0]
    v_mul_f32 v190, v190, v222
    v_mfma_f32_16x16x32_bf16 v[144:147], v[196:199], a[140:143], v[144:147]
    v_cvt_scalef32_pk_bf16_fp4 v208, v64, s75 op_sel:[0,0,0]
    v_cvt_scalef32_pk_bf16_fp4 v209, v64, s75 op_sel:[1,0,0]
    v_mfma_f32_16x16x32_bf16 v[148:151], v[200:203], a[128:131], v[148:151]
    v_mul_f32 v175, v175, v219
    v_cvt_scalef32_pk_bf16_fp4 v210, v64, s75 op_sel:[0,1,0]
    v_mfma_f32_16x16x32_bf16 v[152:155], v[200:203], a[132:135], v[152:155]
    v_cvt_scalef32_pk_bf16_fp4 v211, v64, s75 op_sel:[1,1,0]
    v_mul_f32 v191, v191, v223
    v_mfma_f32_16x16x32_bf16 v[156:159], v[200:203], a[136:139], v[156:159]
    ds_read_b128 v[232:235], v254 offset:0
    v_mfma_f32_16x16x32_bf16 v[160:163], v[200:203], a[140:143], v[160:163]
    v_cvt_scalef32_pk_bf16_fp4 v196, v61, s75 op_sel:[0,0,0]
    v_cvt_scalef32_pk_bf16_fp4 v197, v61, s75 op_sel:[1,0,0]
    v_mfma_f32_16x16x32_bf16 v[132:135], v[204:207], a[144:147], v[132:135]
    v_cvt_pk_bf16_f32 v224, v172, v188
    v_cvt_scalef32_pk_bf16_fp4 v198, v61, s75 op_sel:[0,1,0]
    v_mfma_f32_16x16x32_bf16 v[136:139], v[204:207], a[148:151], v[136:139]
    v_cvt_scalef32_pk_bf16_fp4 v199, v61, s75 op_sel:[1,1,0]
    v_cvt_pk_bf16_f32 v225, v173, v189
    v_mfma_f32_16x16x32_bf16 v[140:143], v[204:207], a[152:155], v[140:143]
    v_cvt_scalef32_pk_bf16_fp4 v200, v65, s75 op_sel:[0,0,0]
    v_cvt_scalef32_pk_bf16_fp4 v201, v65, s75 op_sel:[1,0,0]
    v_mfma_f32_16x16x32_bf16 v[144:147], v[204:207], a[156:159], v[144:147]
    s_waitcnt lgkmcnt(0)
    v_cvt_pk_bf16_f32 v226, v174, v190
    v_mfma_f32_16x16x32_bf16 v[148:151], v[208:211], a[144:147], v[148:151]
    buffer_store_dwordx4 v[232:235], v247, s[36:39], s56 offen sc1
    v_mfma_f32_16x16x32_bf16 v[152:155], v[208:211], a[148:151], v[152:155]
    v_cvt_scalef32_pk_bf16_fp4 v202, v65, s75 op_sel:[0,1,0]
    v_cvt_scalef32_pk_bf16_fp4 v203, v65, s75 op_sel:[1,1,0]
    v_mfma_f32_16x16x32_bf16 v[156:159], v[208:211], a[152:155], v[156:159]
    v_cvt_pk_bf16_f32 v227, v175, v191
    v_cvt_scalef32_pk_bf16_fp4 v204, v62, s75 op_sel:[0,0,0]
    v_mfma_f32_16x16x32_bf16 v[160:163], v[208:211], a[156:159], v[160:163]
    v_cvt_scalef32_pk_bf16_fp4 v205, v62, s75 op_sel:[1,0,0]
    v_cvt_scalef32_pk_bf16_fp4 v206, v62, s75 op_sel:[0,1,0]
    v_mfma_f32_16x16x32_bf16 v[132:135], v[196:199], a[160:163], v[132:135]
    ds_write_b128 v252, v[224:227] offset:4096
    v_mfma_f32_16x16x32_bf16 v[136:139], v[196:199], a[164:167], v[136:139]
    v_cvt_scalef32_pk_bf16_fp4 v207, v62, s75 op_sel:[1,1,0]
    v_mul_f32 v176, v176, v216
    v_mfma_f32_16x16x32_bf16 v[140:143], v[196:199], a[168:171], v[140:143]
    v_cvt_scalef32_pk_bf16_fp4 v208, v66, s75 op_sel:[0,0,0]
    v_cvt_scalef32_pk_bf16_fp4 v209, v66, s75 op_sel:[1,0,0]
    v_mfma_f32_16x16x32_bf16 v[144:147], v[196:199], a[172:175], v[144:147]
    v_mul_f32 v192, v192, v220
    v_cvt_scalef32_pk_bf16_fp4 v210, v66, s75 op_sel:[0,1,0]
    v_mfma_f32_16x16x32_bf16 v[148:151], v[200:203], a[160:163], v[148:151]
    v_cvt_scalef32_pk_bf16_fp4 v211, v66, s75 op_sel:[1,1,0]
    v_mul_f32 v177, v177, v217
    v_mfma_f32_16x16x32_bf16 v[152:155], v[200:203], a[164:167], v[152:155]
    v_cvt_scalef32_pk_bf16_fp4 v196, v68, s75 op_sel:[0,0,0]
    v_cvt_scalef32_pk_bf16_fp4 v197, v68, s75 op_sel:[1,0,0]
    v_mfma_f32_16x16x32_bf16 v[156:159], v[200:203], a[168:171], v[156:159]
    v_mul_f32 v193, v193, v221
    v_cvt_scalef32_pk_bf16_fp4 v198, v68, s75 op_sel:[0,1,0]
    v_mfma_f32_16x16x32_bf16 v[160:163], v[200:203], a[172:175], v[160:163]
    v_cvt_scalef32_pk_bf16_fp4 v199, v68, s75 op_sel:[1,1,0]
    v_mul_f32 v178, v178, v218
    v_mfma_f32_16x16x32_bf16 v[132:135], v[204:207], a[176:179], v[132:135]
    v_cvt_scalef32_pk_bf16_fp4 v200, v72, s75 op_sel:[0,0,0]
    v_cvt_scalef32_pk_bf16_fp4 v201, v72, s75 op_sel:[1,0,0]
    v_mfma_f32_16x16x32_bf16 v[136:139], v[204:207], a[180:183], v[136:139]
    v_mul_f32 v194, v194, v222
    v_cvt_scalef32_pk_bf16_fp4 v202, v72, s75 op_sel:[0,1,0]
    v_mfma_f32_16x16x32_bf16 v[140:143], v[204:207], a[184:187], v[140:143]
    v_cvt_scalef32_pk_bf16_fp4 v203, v72, s75 op_sel:[1,1,0]
    v_mul_f32 v179, v179, v219
    v_mfma_f32_16x16x32_bf16 v[144:147], v[204:207], a[188:191], v[144:147]
    v_cvt_scalef32_pk_bf16_fp4 v204, v69, s75 op_sel:[0,0,0]
    v_cvt_scalef32_pk_bf16_fp4 v205, v69, s75 op_sel:[1,0,0]
    v_mfma_f32_16x16x32_bf16 v[148:151], v[208:211], a[176:179], v[148:151]
    v_mul_f32 v195, v195, v223
    v_cvt_scalef32_pk_bf16_fp4 v206, v69, s75 op_sel:[0,1,0]
    v_mfma_f32_16x16x32_bf16 v[152:155], v[208:211], a[180:183], v[152:155]
    v_cvt_scalef32_pk_bf16_fp4 v207, v69, s75 op_sel:[1,1,0]
    v_cvt_pk_bf16_f32 v228, v176, v192
    v_mfma_f32_16x16x32_bf16 v[156:159], v[208:211], a[184:187], v[156:159]
    ds_read_b128 v[236:239], v254 offset:1024
    v_mfma_f32_16x16x32_bf16 v[160:163], v[208:211], a[188:191], v[160:163]
    v_cvt_scalef32_pk_bf16_fp4 v208, v73, s75 op_sel:[0,0,0]
    v_cvt_scalef32_pk_bf16_fp4 v209, v73, s75 op_sel:[1,0,0]
    v_mfma_f32_16x16x32_bf16 v[132:135], v[196:199], a[192:195], v[132:135]
    v_cvt_pk_bf16_f32 v229, v177, v193
    v_cvt_scalef32_pk_bf16_fp4 v210, v73, s75 op_sel:[0,1,0]
    v_mfma_f32_16x16x32_bf16 v[136:139], v[196:199], a[196:199], v[136:139]
    v_cvt_scalef32_pk_bf16_fp4 v211, v73, s75 op_sel:[1,1,0]
    v_cvt_pk_bf16_f32 v230, v178, v194
    v_mfma_f32_16x16x32_bf16 v[140:143], v[196:199], a[200:203], v[140:143]
    v_cvt_pk_bf16_f32 v231, v179, v195
    v_mfma_f32_16x16x32_bf16 v[144:147], v[196:199], a[204:207], v[144:147]
    s_waitcnt lgkmcnt(0)
    v_cvt_scalef32_pk_bf16_fp4 v196, v70, s75 op_sel:[0,0,0]
    v_mfma_f32_16x16x32_bf16 v[148:151], v[200:203], a[192:195], v[148:151]
    v_cvt_scalef32_pk_bf16_fp4 v197, v70, s75 op_sel:[1,0,0]
    v_cvt_scalef32_pk_bf16_fp4 v198, v70, s75 op_sel:[0,1,0]
    v_mfma_f32_16x16x32_bf16 v[152:155], v[200:203], a[196:199], v[152:155]
    buffer_store_dwordx4 v[236:239], v248, s[36:39], s56 offen sc1
    v_mfma_f32_16x16x32_bf16 v[156:159], v[200:203], a[200:203], v[156:159]
    v_cvt_scalef32_pk_bf16_fp4 v199, v70, s75 op_sel:[1,1,0]
    v_mfma_f32_16x16x32_bf16 v[160:163], v[200:203], a[204:207], v[160:163]
    ds_write_b128 v252, v[228:231] offset:6144
    v_mfma_f32_16x16x32_bf16 v[132:135], v[204:207], a[208:211], v[132:135]
    v_cvt_scalef32_pk_bf16_fp4 v200, v74, s75 op_sel:[0,0,0]
    v_cvt_scalef32_pk_bf16_fp4 v201, v74, s75 op_sel:[1,0,0]
    v_mfma_f32_16x16x32_bf16 v[136:139], v[204:207], a[212:215], v[136:139]
    v_cvt_scalef32_pk_bf16_fp4 v202, v74, s75 op_sel:[0,1,0]
    v_cvt_scalef32_pk_bf16_fp4 v203, v74, s75 op_sel:[1,1,0]
    v_mfma_f32_16x16x32_bf16 v[140:143], v[204:207], a[216:219], v[140:143]
    ds_read_b128 v[232:235], v254 offset:2048
    v_mfma_f32_16x16x32_bf16 v[144:147], v[204:207], a[220:223], v[144:147]
    v_cvt_scalef32_pk_bf16_fp4 v204, v76, s75 op_sel:[0,0,0]
    v_cvt_scalef32_pk_bf16_fp4 v205, v76, s75 op_sel:[1,0,0]
    v_mfma_f32_16x16x32_bf16 v[148:151], v[208:211], a[208:211], v[148:151]
    v_cvt_scalef32_pk_bf16_fp4 v206, v76, s75 op_sel:[0,1,0]
    v_cvt_scalef32_pk_bf16_fp4 v207, v76, s75 op_sel:[1,1,0]
    v_mfma_f32_16x16x32_bf16 v[152:155], v[208:211], a[212:215], v[152:155]
    ds_read_b128 v[236:239], v254 offset:3072
    v_mfma_f32_16x16x32_bf16 v[156:159], v[208:211], a[216:219], v[156:159]
    v_mfma_f32_16x16x32_bf16 v[160:163], v[208:211], a[220:223], v[160:163]
    v_cvt_scalef32_pk_bf16_fp4 v208, v80, s75 op_sel:[0,0,0]
    v_cvt_scalef32_pk_bf16_fp4 v209, v80, s75 op_sel:[1,0,0]
    v_mfma_f32_16x16x32_bf16 v[132:135], v[196:199], a[224:227], v[132:135]
    s_waitcnt vmcnt(2)
    v_xad_u32 v249, v87, s53, 0
    v_mfma_f32_16x16x32_bf16 v[136:139], v[196:199], a[228:231], v[136:139]
    v_xad_u32 v249, v91, s53, v249
    v_xad_u32 v249, v95, s53, v249
    v_mfma_f32_16x16x32_bf16 v[140:143], v[196:199], a[232:235], v[140:143]
    v_xad_u32 v249, v99, s53, v249
    v_cvt_scalef32_pk_bf16_fp4 v210, v80, s75 op_sel:[0,1,0]
    v_mfma_f32_16x16x32_bf16 v[144:147], v[196:199], a[236:239], v[144:147]
    v_cvt_scalef32_pk_bf16_fp4 v211, v80, s75 op_sel:[1,1,0]
    v_xad_u32 v249, v103, s53, v249
    v_mfma_f32_16x16x32_bf16 v[148:151], v[200:203], a[224:227], v[148:151]
    v_cvt_scalef32_pk_bf16_fp4 v196, v77, s75 op_sel:[0,0,0]
    v_cvt_scalef32_pk_bf16_fp4 v197, v77, s75 op_sel:[1,0,0]
    v_mfma_f32_16x16x32_bf16 v[152:155], v[200:203], a[228:231], v[152:155]
    v_xad_u32 v249, v107, s53, v249
    v_cvt_scalef32_pk_bf16_fp4 v198, v77, s75 op_sel:[0,1,0]
    v_mfma_f32_16x16x32_bf16 v[156:159], v[200:203], a[232:235], v[156:159]
    v_cvt_scalef32_pk_bf16_fp4 v199, v77, s75 op_sel:[1,1,0]
    v_xad_u32 v249, v111, s53, v249
    v_mfma_f32_16x16x32_bf16 v[160:163], v[200:203], a[236:239], v[160:163]
    v_cvt_scalef32_pk_bf16_fp4 v200, v81, s75 op_sel:[0,0,0]
    v_cvt_scalef32_pk_bf16_fp4 v201, v81, s75 op_sel:[1,0,0]
    v_mfma_f32_16x16x32_bf16 v[132:135], v[204:207], a[240:243], v[132:135]
    v_xad_u32 v249, v115, s53, v249
    v_cvt_scalef32_pk_bf16_fp4 v202, v81, s75 op_sel:[0,1,0]
    v_mfma_f32_16x16x32_bf16 v[136:139], v[204:207], a[244:247], v[136:139]
    v_cvt_scalef32_pk_bf16_fp4 v203, v81, s75 op_sel:[1,1,0]
    v_xad_u32 v249, v119, s53, v249
    v_mfma_f32_16x16x32_bf16 v[140:143], v[204:207], a[248:251], v[140:143]
    v_xad_u32 v249, v123, s53, v249
    v_xad_u32 v249, v127, s53, v249
    v_mfma_f32_16x16x32_bf16 v[144:147], v[204:207], a[252:255], v[144:147]
    v_xad_u32 v249, v131, s53, v249
    v_cvt_scalef32_pk_bf16_fp4 v204, v78, s75 op_sel:[0,0,0]
    v_mfma_f32_16x16x32_bf16 v[148:151], v[208:211], a[240:243], v[148:151]
    v_cvt_scalef32_pk_bf16_fp4 v205, v78, s75 op_sel:[1,0,0]
    v_cmp_ne_u32 vcc, 0, v249
    v_mfma_f32_16x16x32_bf16 v[152:155], v[208:211], a[244:247], v[152:155]
    v_cvt_scalef32_pk_bf16_fp4 v206, v78, s75 op_sel:[0,1,0]
    v_cvt_scalef32_pk_bf16_fp4 v207, v78, s75 op_sel:[1,1,0]
    v_mfma_f32_16x16x32_bf16 v[156:159], v[208:211], a[248:251], v[156:159]
    s_cbranch_vccnz K_retry3
K_back3:
    s_waitcnt lgkmcnt(1)
    v_mfma_f32_16x16x32_bf16 v[160:163], v[208:211], a[252:255], v[160:163]
    v_cvt_scalef32_pk_bf16_fp4 v208, v82, s75 op_sel:[0,0,0]
    v_cvt_scalef32_pk_bf16_fp4 v209, v82, s75 op_sel:[1,0,0]
    v_mfma_f32_16x16x32_bf16 v[132:135], v[196:199], v[4:7], v[132:135]
    v_cvt_scalef32_pk_bf16_fp4 v210, v82, s75 op_sel:[0,1,0]
    v_cvt_scalef32_pk_bf16_fp4 v211, v82, s75 op_sel:[1,1,0]
    v_mfma_f32_16x16x32_bf16 v[136:139], v[196:199], v[8:11], v[136:139]
    buffer_store_dwordx4 v[232:235], v247, s[36:39], s57 offen sc1
    v_mfma_f32_16x16x32_bf16 v[140:143], v[196:199], v[12:15], v[140:143]
    s_waitcnt lgkmcnt(0)
    v_mfma_f32_16x16x32_bf16 v[144:147], v[196:199], v[16:19], v[144:147]
    v_cvt_scalef32_pk_bf16_fp4 v196, v84, s75 op_sel:[0,0,0]
    v_cvt_scalef32_pk_bf16_fp4 v197, v84, s75 op_sel:[1,0,0]
    v_mfma_f32_16x16x32_bf16 v[148:151], v[200:203], v[4:7], v[148:151]
    v_cvt_scalef32_pk_bf16_fp4 v198, v84, s75 op_sel:[0,1,0]
    v_cvt_scalef32_pk_bf16_fp4 v199, v84, s75 op_sel:[1,1,0]
    v_mfma_f32_16x16x32_bf16 v[152:155], v[200:203], v[8:11], v[152:155]
    buffer_store_dwordx4 v[236:239], v248, s[36:39], s57 offen sc1
    v_mfma_f32_16x16x32_bf16 v[156:159], v[200:203], v[12:15], v[156:159]
    ds_read_b128 v[232:235], v254 offset:4096
    v_mfma_f32_16x16x32_bf16 v[160:163], v[200:203], v[16:19], v[160:163]
    v_cvt_scalef32_pk_bf16_fp4 v200, v88, s75 op_sel:[0,0,0]
    v_cvt_scalef32_pk_bf16_fp4 v201, v88, s75 op_sel:[1,0,0]
    v_mfma_f32_16x16x32_bf16 v[132:135], v[204:207], v[20:23], v[132:135]
    v_cvt_scalef32_pk_bf16_fp4 v202, v88, s75 op_sel:[0,1,0]
    v_cvt_scalef32_pk_bf16_fp4 v203, v88, s75 op_sel:[1,1,0]
    v_mfma_f32_16x16x32_bf16 v[136:139], v[204:207], v[24:27], v[136:139]
    ds_read_b128 v[236:239], v254 offset:5120
    v_mfma_f32_16x16x32_bf16 v[140:143], v[204:207], v[28:31], v[140:143]
    v_mfma_f32_16x16x32_bf16 v[144:147], v[204:207], v[32:35], v[144:147]
    v_cvt_scalef32_pk_bf16_fp4 v204, v85, s75 op_sel:[0,0,0]
    v_cvt_scalef32_pk_bf16_fp4 v205, v85, s75 op_sel:[1,0,0]
    v_mfma_f32_16x16x32_bf16 v[148:151], v[208:211], v[20:23], v[148:151]
    v_cvt_scalef32_pk_bf16_fp4 v206, v85, s75 op_sel:[0,1,0]
    v_cvt_scalef32_pk_bf16_fp4 v207, v85, s75 op_sel:[1,1,0]
    v_mfma_f32_16x16x32_bf16 v[152:155], v[208:211], v[24:27], v[152:155]
    s_waitcnt lgkmcnt(1)
    v_mfma_f32_16x16x32_bf16 v[156:159], v[208:211], v[28:31], v[156:159]
    buffer_store_dwordx4 v[232:235], v247, s[36:39], s58 offen sc1
    v_mfma_f32_16x16x32_bf16 v[160:163], v[208:211], v[32:35], v[160:163]
    v_cvt_scalef32_pk_bf16_fp4 v208, v89, s75 op_sel:[0,0,0]
    v_cvt_scalef32_pk_bf16_fp4 v209, v89, s75 op_sel:[1,0,0]
    v_mfma_f32_16x16x32_bf16 v[164:167], v[196:199], a[0:3], 0
    s_add_u32 s64, s63, 0
    s_add_u32 s65, s63, 4096
    v_mfma_f32_16x16x32_bf16 v[168:171], v[196:199], a[4:7], 0
    v_cvt_scalef32_pk_bf16_fp4 v210, v89, s75 op_sel:[0,1,0]
    v_cvt_scalef32_pk_bf16_fp4 v211, v89, s75 op_sel:[1,1,0]
    v_mfma_f32_16x16x32_bf16 v[172:175], v[196:199], a[8:11], 0
    buffer_load_dwordx4 v[36:39], v244, s[40:43], s64 offen sc1
    v_mfma_f32_16x16x32_bf16 v[176:179], v[196:199], a[12:15], 0
    v_lshlrev_b32 v216, 16, v212
    v_and_b32 v220, 0xffff0000, v212
    v_mfma_f32_16x16x32_bf16 v[180:183], v[200:203], a[0:3], 0
    v_lshlrev_b32 v217, 16, v213
    v_and_b32 v221, 0xffff0000, v213
    v_mfma_f32_16x16x32_bf16 v[184:187], v[200:203], a[4:7], 0
    v_lshlrev_b32 v218, 16, v214
    v_and_b32 v222, 0xffff0000, v214
    v_mfma_f32_16x16x32_bf16 v[188:191], v[200:203], a[8:11], 0
    v_lshlrev_b32 v219, 16, v215
    v_and_b32 v223, 0xffff0000, v215
    v_mfma_f32_16x16x32_bf16 v[192:195], v[200:203], a[12:15], 0
    v_mul_f32 v132, v132, v216
    v_mul_f32 v148, v148, v220
    v_mfma_f32_16x16x32_bf16 v[164:167], v[204:207], a[16:19], v[164:167]
    v_mul_f32 v133, v133, v217
    v_cvt_scalef32_pk_bf16_fp4 v196, v86, s75 op_sel:[0,0,0]
    v_mfma_f32_16x16x32_bf16 v[168:171], v[204:207], a[20:23], v[168:171]
    v_cvt_scalef32_pk_bf16_fp4 v197, v86, s75 op_sel:[1,0,0]
    v_cvt_scalef32_pk_bf16_fp4 v198, v86, s75 op_sel:[0,1,0]
    v_mfma_f32_16x16x32_bf16 v[172:175], v[204:207], a[24:27], v[172:175]
    v_cvt_scalef32_pk_bf16_fp4 v199, v86, s75 op_sel:[1,1,0]
    v_mul_f32 v149, v149, v221
    v_mfma_f32_16x16x32_bf16 v[176:179], v[204:207], a[28:31], v[176:179]
    v_mul_f32 v134, v134, v218
    v_cvt_scalef32_pk_bf16_fp4 v200, v90, s75 op_sel:[0,0,0]
    v_mfma_f32_16x16x32_bf16 v[180:183], v[208:211], a[16:19], v[180:183]
    v_cvt_scalef32_pk_bf16_fp4 v201, v90, s75 op_sel:[1,0,0]
    v_cvt_scalef32_pk_bf16_fp4 v202, v90, s75 op_sel:[0,1,0]
    v_mfma_f32_16x16x32_bf16 v[184:187], v[208:211], a[20:23], v[184:187]
    v_cvt_scalef32_pk_bf16_fp4 v203, v90, s75 op_sel:[1,1,0]
    v_mul_f32 v150, v150, v222
    v_mfma_f32_16x16x32_bf16 v[188:191], v[208:211], a[24:27], v[188:191]
    buffer_load_dwordx4 v[40:43], v244, s[40:43], s64 offen offset:1024 sc1
    v_mfma_f32_16x16x32_bf16 v[192:195], v[208:211], a[28:31], v[192:195]
    v_mul_f32 v135, v135, v219
    v_cvt_scalef32_pk_bf16_fp4 v204, v92, s75 op_sel:[0,0,0]
    v_mfma_f32_16x16x32_bf16 v[164:167], v[196:199], a[32:35], v[164:167]
    v_cvt_scalef32_pk_bf16_fp4 v205, v92, s75 op_sel:[1,0,0]
    v_cvt_scalef32_pk_bf16_fp4 v206, v92, s75 op_sel:[0,1,0]
    v_mfma_f32_16x16x32_bf16 v[168:171], v[196:199], a[36:39], v[168:171]
    v_cvt_scalef32_pk_bf16_fp4 v207, v92, s75 op_sel:[1,1,0]
    v_mul_f32 v151, v151, v223
    v_mfma_f32_16x16x32_bf16 v[172:175], v[196:199], a[40:43], v[172:175]
    v_cvt_pk_bf16_f32 v224, v132, v148
    v_cvt_scalef32_pk_bf16_fp4 v208, v96, s75 op_sel:[0,0,0]
    v_mfma_f32_16x16x32_bf16 v[176:179], v[196:199], a[44:47], v[176:179]
    v_cvt_scalef32_pk_bf16_fp4 v209, v96, s75 op_sel:[1,0,0]
    v_cvt_scalef32_pk_bf16_fp4 v210, v96, s75 op_sel:[0,1,0]
    v_mfma_f32_16x16x32_bf16 v[180:183], v[200:203], a[32:35], v[180:183]
    buffer_load_dwordx4 v[44:47], v244, s[40:43], s64 offen offset:2048 sc1
    v_mfma_f32_16x16x32_bf16 v[184:187], v[200:203], a[36:39], v[184:187]
    v_cvt_scalef32_pk_bf16_fp4 v211, v96, s75 op_sel:[1,1,0]
    v_cvt_pk_bf16_f32 v225, v133, v149
    v_mfma_f32_16x16x32_bf16 v[188:191], v[200:203], a[40:43], v[188:191]
    v_cvt_pk_bf16_f32 v226, v134, v150
    v_cvt_scalef32_pk_bf16_fp4 v196, v93, s75 op_sel:[0,0,0]
    v_mfma_f32_16x16x32_bf16 v[192:195], v[200:203], a[44:47], v[192:195]
    v_cvt_scalef32_pk_bf16_fp4 v197, v93, s75 op_sel:[1,0,0]
    v_cvt_scalef32_pk_bf16_fp4 v198, v93, s75 op_sel:[0,1,0]
    v_mfma_f32_16x16x32_bf16 v[164:167], v[204:207], a[48:51], v[164:167]
    v_cvt_scalef32_pk_bf16_fp4 v199, v93, s75 op_sel:[1,1,0]
    v_cvt_pk_bf16_f32 v227, v135, v151
    v_mfma_f32_16x16x32_bf16 v[168:171], v[204:207], a[52:55], v[168:171]
    buffer_load_dwordx4 v[48:51], v244, s[40:43], s64 offen offset:3072 sc1
    v_mfma_f32_16x16x32_bf16 v[172:175], v[204:207], a[56:59], v[172:175]
    ds_write_b128 v245, v[224:227] offset:0
    v_mfma_f32_16x16x32_bf16 v[176:179], v[204:207], a[60:63], v[176:179]
    v_cvt_scalef32_pk_bf16_fp4 v200, v97, s75 op_sel:[0,0,0]
    v_cvt_scalef32_pk_bf16_fp4 v201, v97, s75 op_sel:[1,0,0]
    v_mfma_f32_16x16x32_bf16 v[180:183], v[208:211], a[48:51], v[180:183]
    v_cvt_scalef32_pk_bf16_fp4 v202, v97, s75 op_sel:[0,1,0]
    v_cvt_scalef32_pk_bf16_fp4 v203, v97, s75 op_sel:[1,1,0]
    v_mfma_f32_16x16x32_bf16 v[184:187], v[208:211], a[52:55], v[184:187]
    v_mul_f32 v136, v136, v216
    v_mul_f32 v152, v152, v220
    v_mfma_f32_16x16x32_bf16 v[188:191], v[208:211], a[56:59], v[188:191]
    v_cvt_scalef32_pk_bf16_fp4 v204, v94, s75 op_sel:[0,0,0]
    v_cvt_scalef32_pk_bf16_fp4 v205, v94, s75 op_sel:[1,0,0]
    v_mfma_f32_16x16x32_bf16 v[192:195], v[208:211], a[60:63], v[192:195]
    v_cvt_scalef32_pk_bf16_fp4 v206, v94, s75 op_sel:[0,1,0]
    v_cvt_scalef32_pk_bf16_fp4 v207, v94, s75 op_sel:[1,1,0]
    v_mfma_f32_16x16x32_bf16 v[164:167], v[196:199], a[64:67], v[164:167]
    v_mul_f32 v137, v137, v217
    v_mul_f32 v153, v153, v221
    v_mfma_f32_16x16x32_bf16 v[168:171], v[196:199], a[68:71], v[168:171]
    buffer_load_dwordx4 v[52:55], v244, s[40:43], s65 offen sc1
    v_mfma_f32_16x16x32_bf16 v[172:175], v[196:199], a[72:75], v[172:175]
    v_cvt_scalef32_pk_bf16_fp4 v208, v98, s75 op_sel:[0,0,0]
    v_cvt_scalef32_pk_bf16_fp4 v209, v98, s75 op_sel:[1,0,0]
    v_mfma_f32_16x16x32_bf16 v[176:179], v[196:199], a[76:79], v[176:179]
    v_cvt_scalef32_pk_bf16_fp4 v210, v98, s75 op_sel:[0,1,0]
    v_cvt_scalef32_pk_bf16_fp4 v211, v98, s75 op_sel:[1,1,0]
    v_mfma_f32_16x16x32_bf16 v[180:183], v[200:203], a[64:67], v[180:183]
    v_mul_f32 v138, v138, v218
    v_mul_f32 v154, v154, v222
    v_mfma_f32_16x16x32_bf16 v[184:187], v[200:203], a[68:71], v[184:187]
    v_cvt_scalef32_pk_bf16_fp4 v196, v100, s75 op_sel:[0,0,0]
    v_cvt_scalef32_pk_bf16_fp4 v197, v100, s75 op_sel:[1,0,0]
    v_mfma_f32_16x16x32_bf16 v[188:191], v[200:203], a[72:75], v[188:191]
    v_cvt_scalef32_pk_bf16_fp4 v198, v100, s75 op_sel:[0,1,0]
    v_cvt_scalef32_pk_bf16_fp4 v199, v100, s75 op_sel:[1,1,0]
    v_mfma_f32_16x16x32_bf16 v[192:195], v[200:203], a[76:79], v[192:195]
    v_mul_f32 v139, v139, v219
    v_mul_f32 v155, v155, v223
    v_mfma_f32_16x16x32_bf16 v[164:167], v[204:207], a[80:83], v[164:167]
    buffer_load_dwordx4 v[56:59], v244, s[40:43], s65 offen offset:1024 sc1
    v_mfma_f32_16x16x32_bf16 v[168:171], v[204:207], a[84:87], v[168:171]
    v_cvt_scalef32_pk_bf16_fp4 v200, v104, s75 op_sel:[0,0,0]
    v_cvt_scalef32_pk_bf16_fp4 v201, v104, s75 op_sel:[1,0,0]
    v_mfma_f32_16x16x32_bf16 v[172:175], v[204:207], a[88:91], v[172:175]
    s_add_u32 s51, s67, 576
    v_cvt_scalef32_pk_bf16_fp4 v202, v104, s75 op_sel:[0,1,0]
    v_mfma_f32_16x16x32_bf16 v[176:179], v[204:207], a[92:95], v[176:179]
    v_cvt_scalef32_pk_bf16_fp4 v203, v104, s75 op_sel:[1,1,0]
    v_cvt_pk_bf16_f32 v228, v136, v152
    v_mfma_f32_16x16x32_bf16 v[180:183], v[208:211], a[80:83], v[180:183]
    v_cvt_pk_bf16_f32 v229, v137, v153
    v_cvt_scalef32_pk_bf16_fp4 v204, v101, s75 op_sel:[0,0,0]
    v_mfma_f32_16x16x32_bf16 v[184:187], v[208:211], a[84:87], v[184:187]
    v_cvt_scalef32_pk_bf16_fp4 v205, v101, s75 op_sel:[1,0,0]
    v_cvt_scalef32_pk_bf16_fp4 v206, v101, s75 op_sel:[0,1,0]
    v_mfma_f32_16x16x32_bf16 v[188:191], v[208:211], a[88:91], v[188:191]
    buffer_load_dwordx4 v[212:215], v246, s[28:31], s51 offen
    v_mfma_f32_16x16x32_bf16 v[192:195], v[208:211], a[92:95], v[192:195]
    v_cvt_scalef32_pk_bf16_fp4 v207, v101, s75 op_sel:[1,1,0]
    v_cvt_pk_bf16_f32 v230, v138, v154
    v_mfma_f32_16x16x32_bf16 v[164:167], v[196:199], a[96:99], v[164:167]
    v_cvt_pk_bf16_f32 v231, v139, v155
    v_cvt_scalef32_pk_bf16_fp4 v208, v105, s75 op_sel:[0,0,0]
    v_mfma_f32_16x16x32_bf16 v[168:171], v[196:199], a[100:103], v[168:171]
    v_cvt_scalef32_pk_bf16_fp4 v209, v105, s75 op_sel:[1,0,0]
    v_cvt_scalef32_pk_bf16_fp4 v210, v105, s75 op_sel:[0,1,0]
    v_mfma_f32_16x16x32_bf16 v[172:175], v[196:199], a[104:107], v[172:175]
    v_cvt_scalef32_pk_bf16_fp4 v211, v105, s75 op_sel:[1,1,0]
    v_mul_f32 v140, v140, v216
    v_mfma_f32_16x16x32_bf16 v[176:179], v[196:199], a[108:111], v[176:179]
    ds_write_b128 v245, v[228:231] offset:1024
    v_mfma_f32_16x16x32_bf16 v[180:183], v[200:203], a[96:99], v[180:183]
    v_cvt_scalef32_pk_bf16_fp4 v196, v102, s75 op_sel:[0,0,0]
    v_cvt_scalef32_pk_bf16_fp4 v197, v102, s75 op_sel:[1,0,0]
    v_mfma_f32_16x16x32_bf16 v[184:187], v[200:203], a[100:103], v[184:187]
    v_cvt_scalef32_pk_bf16_fp4 v198, v102, s75 op_sel:[0,1,0]
    v_cvt_scalef32_pk_bf16_fp4 v199, v102, s75 op_sel:[1,1,0]
    v_mfma_f32_16x16x32_bf16 v[188:191], v[200:203], a[104:107], v[188:191]
    v_mul_f32 v156, v156, v220
    v_mul_f32 v141, v141, v217
    v_mfma_f32_16x16x32_bf16 v[192:195], v[200:203], a[108:111], v[192:195]
    v_cvt_scalef32_pk_bf16_fp4 v200, v106, s75 op_sel:[0,0,0]
    v_cvt_scalef32_pk_bf16_fp4 v201, v106, s75 op_sel:[1,0,0]
    v_mfma_f32_16x16x32_bf16 v[164:167], v[204:207], a[112:115], v[164:167]
    v_cvt_scalef32_pk_bf16_fp4 v202, v106, s75 op_sel:[0,1,0]
    v_cvt_scalef32_pk_bf16_fp4 v203, v106, s75 op_sel:[1,1,0]
    v_mfma_f32_16x16x32_bf16 v[168:171], v[204:207], a[116:119], v[168:171]
    v_mul_f32 v157, v157, v221
    v_mul_f32 v142, v142, v218
    v_mfma_f32_16x16x32_bf16 v[172:175], v[204:207], a[120:123], v[172:175]
    v_mul_f32 v158, v158, v222
    v_mul_f32 v143, v143, v219
    v_mfma_f32_16x16x32_bf16 v[176:179], v[204:207], a[124:127], v[176:179]
    v_cvt_scalef32_pk_bf16_fp4 v204, v108, s75 op_sel:[0,0,0]
    v_cvt_scalef32_pk_bf16_fp4 v205, v108, s75 op_sel:[1,0,0]
    v_mfma_f32_16x16x32_bf16 v[180:183], v[208:211], a[112:115], v[180:183]
    v_cvt_scalef32_pk_bf16_fp4 v206, v108, s75 op_sel:[0,1,0]
    v_cvt_scalef32_pk_bf16_fp4 v207, v108, s75 op_sel:[1,1,0]
    v_mfma_f32_16x16x32_bf16 v[184:187], v[208:211], a[116:119], v[184:187]
    v_mul_f32 v159, v159, v223
    v_cvt_pk_bf16_f32 v224, v140, v156
    v_mfma_f32_16x16x32_bf16 v[188:191], v[208:211], a[120:123], v[188:191]
    s_waitcnt lgkmcnt(2)
    v_cvt_pk_bf16_f32 v225, v141, v157
    v_mfma_f32_16x16x32_bf16 v[192:195], v[208:211], a[124:127], v[192:195]
    v_cvt_scalef32_pk_bf16_fp4 v208, v112, s75 op_sel:[0,0,0]
    v_cvt_scalef32_pk_bf16_fp4 v209, v112, s75 op_sel:[1,0,0]
    v_mfma_f32_16x16x32_bf16 v[164:167], v[196:199], a[128:131], v[164:167]
    v_cvt_scalef32_pk_bf16_fp4 v210, v112, s75 op_sel:[0,1,0]
    v_cvt_scalef32_pk_bf16_fp4 v211, v112, s75 op_sel:[1,1,0]
    v_mfma_f32_16x16x32_bf16 v[168:171], v[196:199], a[132:135], v[168:171]
    buffer_store_dwordx4 v[236:239], v248, s[36:39], s58 offen sc1
    v_mfma_f32_16x16x32_bf16 v[172:175], v[196:199], a[136:139], v[172:175]
    v_cvt_pk_bf16_f32 v226, v142, v158
    v_cvt_pk_bf16_f32 v227, v143, v159
    v_mfma_f32_16x16x32_bf16 v[176:179], v[196:199], a[140:143], v[176:179]
    v_cvt_scalef32_pk_bf16_fp4 v196, v109, s75 op_sel:[0,0,0]
    v_cvt_scalef32_pk_bf16_fp4 v197, v109, s75 op_sel:[1,0,0]
    v_mfma_f32_16x16x32_bf16 v[180:183], v[200:203], a[128:131], v[180:183]
    v_cvt_scalef32_pk_bf16_fp4 v198, v109, s75 op_sel:[0,1,0]
    v_cvt_scalef32_pk_bf16_fp4 v199, v109, s75 op_sel:[1,1,0]
    v_mfma_f32_16x16x32_bf16 v[184:187], v[200:203], a[132:135], v[184:187]
    ds_write_b128 v245, v[224:227] offset:2048
    v_mfma_f32_16x16x32_bf16 v[188:191], v[200:203], a[136:139], v[188:191]
    v_mul_f32 v144, v144, v216
    v_mul_f32 v160, v160, v220
    v_mfma_f32_16x16x32_bf16 v[192:195], v[200:203], a[140:143], v[192:195]
    v_cvt_scalef32_pk_bf16_fp4 v200, v113, s75 op_sel:[0,0,0]
    v_cvt_scalef32_pk_bf16_fp4 v201, v113, s75 op_sel:[1,0,0]
    v_mfma_f32_16x16x32_bf16 v[164:167], v[204:207], a[144:147], v[164:167]
    v_cvt_scalef32_pk_bf16_fp4 v202, v113, s75 op_sel:[0,1,0]
    v_cvt_scalef32_pk_bf16_fp4 v203, v113, s75 op_sel:[1,1,0]
    v_mfma_f32_16x16x32_bf16 v[168:171], v[204:207], a[148:151], v[168:171]
    v_mul_f32 v145, v145, v217
    v_mul_f32 v161, v161, v221
    v_mfma_f32_16x16x32_bf16 v[172:175], v[204:207], a[152:155], v[172:175]
    v_mul_f32 v146, v146, v218
    v_mul_f32 v162, v162, v222
    v_mfma_f32_16x16x32_bf16 v[176:179], v[204:207], a[156:159], v[176:179]
    v_cvt_scalef32_pk_bf16_fp4 v204, v110, s75 op_sel:[0,0,0]
    v_cvt_scalef32_pk_bf16_fp4 v205, v110, s75 op_sel:[1,0,0]
    v_mfma_f32_16x16x32_bf16 v[180:183], v[208:211], a[144:147], v[180:183]
    v_cvt_scalef32_pk_bf16_fp4 v206, v110, s75 op_sel:[0,1,0]
    v_cvt_scalef32_pk_bf16_fp4 v207, v110, s75 op_sel:[1,1,0]
    v_mfma_f32_16x16x32_bf16 v[184:187], v[208:211], a[148:151], v[184:187]
    v_mul_f32 v147, v147, v219
    v_mul_f32 v163, v163, v223
    v_mfma_f32_16x16x32_bf16 v[188:191], v[208:211], a[152:155], v[188:191]
    ds_read_b128 v[232:235], v254 offset:6144
    v_mfma_f32_16x16x32_bf16 v[192:195], v[208:211], a[156:159], v[192:195]
    v_cvt_scalef32_pk_bf16_fp4 v208, v114, s75 op_sel:[0,0,0]
    v_cvt_scalef32_pk_bf16_fp4 v209, v114, s75 op_sel:[1,0,0]
    v_mfma_f32_16x16x32_bf16 v[164:167], v[196:199], a[160:163], v[164:167]
    v_cvt_scalef32_pk_bf16_fp4 v210, v114, s75 op_sel:[0,1,0]
    v_cvt_scalef32_pk_bf16_fp4 v211, v114, s75 op_sel:[1,1,0]
    v_mfma_f32_16x16x32_bf16 v[168:171], v[196:199], a[164:167], v[168:171]
    v_cvt_pk_bf16_f32 v228, v144, v160
    v_cvt_pk_bf16_f32 v229, v145, v161
    v_mfma_f32_16x16x32_bf16 v[172:175], v[196:199], a[168:171], v[172:175]
    v_cvt_pk_bf16_f32 v230, v146, v162
    v_cvt_pk_bf16_f32 v231, v147, v163
    v_mfma_f32_16x16x32_bf16 v[176:179], v[196:199], a[172:175], v[176:179]
    v_cvt_scalef32_pk_bf16_fp4 v196, v116, s75 op_sel:[0,0,0]
    v_cvt_scalef32_pk_bf16_fp4 v197, v116, s75 op_sel:[1,0,0]
    v_mfma_f32_16x16x32_bf16 v[180:183], v[200:203], a[160:163], v[180:183]
    v_cvt_scalef32_pk_bf16_fp4 v198, v116, s75 op_sel:[0,1,0]
    v_cvt_scalef32_pk_bf16_fp4 v199, v116, s75 op_sel:[1,1,0]
    v_mfma_f32_16x16x32_bf16 v[184:187], v[200:203], a[164:167], v[184:187]
    s_waitcnt lgkmcnt(0)
    v_mfma_f32_16x16x32_bf16 v[188:191], v[200:203], a[168:171], v[188:191]
    buffer_store_dwordx4 v[232:235], v247, s[36:39], s59 offen sc1
    v_mfma_f32_16x16x32_bf16 v[192:195], v[200:203], a[172:175], v[192:195]
    v_cvt_scalef32_pk_bf16_fp4 v200, v120, s75 op_sel:[0,0,0]
    v_cvt_scalef32_pk_bf16_fp4 v201, v120, s75 op_sel:[1,0,0]
    v_mfma_f32_16x16x32_bf16 v[164:167], v[204:207], a[176:179], v[164:167]
    v_cvt_scalef32_pk_bf16_fp4 v202, v120, s75 op_sel:[0,1,0]
    v_cvt_scalef32_pk_bf16_fp4 v203, v120, s75 op_sel:[1,1,0]
    v_mfma_f32_16x16x32_bf16 v[168:171], v[204:207], a[180:183], v[168:171]
    ds_write_b128 v245, v[228:231] offset:3072
    v_mfma_f32_16x16x32_bf16 v[172:175], v[204:207], a[184:187], v[172:175]
    ds_read_b128 v[236:239], v254 offset:7168
    ds_read_b128 v[232:235], v254 offset:8192
    v_mfma_f32_16x16x32_bf16 v[176:179], v[204:207], a[188:191], v[176:179]
    v_cvt_scalef32_pk_bf16_fp4 v204, v117, s75 op_sel:[0,0,0]
    v_cvt_scalef32_pk_bf16_fp4 v205, v117, s75 op_sel:[1,0,0]
    v_mfma_f32_16x16x32_bf16 v[180:183], v[208:211], a[176:179], v[180:183]
    v_cvt_scalef32_pk_bf16_fp4 v206, v117, s75 op_sel:[0,1,0]
    v_cvt_scalef32_pk_bf16_fp4 v207, v117, s75 op_sel:[1,1,0]
    v_mfma_f32_16x16x32_bf16 v[184:187], v[208:211], a[180:183], v[184:187]
    v_mfma_f32_16x16x32_bf16 v[188:191], v[208:211], a[184:187], v[188:191]
    v_mfma_f32_16x16x32_bf16 v[192:195], v[208:211], a[188:191], v[192:195]
    s_waitcnt lgkmcnt(0)
    v_cvt_scalef32_pk_bf16_fp4 v208, v121, s75 op_sel:[0,0,0]
    v_mfma_f32_16x16x32_bf16 v[164:167], v[196:199], a[192:195], v[164:167]
    v_cvt_scalef32_pk_bf16_fp4 v209, v121, s75 op_sel:[1,0,0]
    v_cvt_scalef32_pk_bf16_fp4 v210, v121, s75 op_sel:[0,1,0]
    v_mfma_f32_16x16x32_bf16 v[168:171], v[196:199], a[196:199], v[168:171]
    v_cvt_scalef32_pk_bf16_fp4 v211, v121, s75 op_sel:[1,1,0]
    s_waitcnt lgkmcnt(1)
    v_mfma_f32_16x16x32_bf16 v[172:175], v[196:199], a[200:203], v[172:175]
    buffer_store_dwordx4 v[236:239], v248, s[36:39], s59 offen sc1
    buffer_store_dwordx4 v[232:235], v253, s[36:39], s56 offen offset:512 sc1
    v_mfma_f32_16x16x32_bf16 v[176:179], v[196:199], a[204:207], v[176:179]
    ds_read_b128 v[236:239], v254 offset:9216
    v_mfma_f32_16x16x32_bf16 v[180:183], v[200:203], a[192:195], v[180:183]
    ds_read_b128 v[232:235], v254 offset:10240
    v_mfma_f32_16x16x32_bf16 v[184:187], v[200:203], a[196:199], v[184:187]
    v_cvt_scalef32_pk_bf16_fp4 v196, v118, s75 op_sel:[0,0,0]
    v_cvt_scalef32_pk_bf16_fp4 v197, v118, s75 op_sel:[1,0,0]
    v_mfma_f32_16x16x32_bf16 v[188:191], v[200:203], a[200:203], v[188:191]
    v_cvt_scalef32_pk_bf16_fp4 v198, v118, s75 op_sel:[0,1,0]
    v_cvt_scalef32_pk_bf16_fp4 v199, v118, s75 op_sel:[1,1,0]
    v_mfma_f32_16x16x32_bf16 v[192:195], v[200:203], a[204:207], v[192:195]
    v_cvt_scalef32_pk_bf16_fp4 v200, v122, s75 op_sel:[0,0,0]
    v_cvt_scalef32_pk_bf16_fp4 v201, v122, s75 op_sel:[1,0,0]
    v_mfma_f32_16x16x32_bf16 v[164:167], v[204:207], a[208:211], v[164:167]
    s_waitcnt lgkmcnt(1)
    v_cvt_scalef32_pk_bf16_fp4 v202, v122, s75 op_sel:[0,1,0]
    buffer_store_dwordx4 v[236:239], v253, s[36:39], s57 offen offset:512 sc1
    v_mfma_f32_16x16x32_bf16 v[168:171], v[204:207], a[212:215], v[168:171]
    v_cvt_scalef32_pk_bf16_fp4 v203, v122, s75 op_sel:[1,1,0]
    s_waitcnt lgkmcnt(0)
    v_mfma_f32_16x16x32_bf16 v[172:175], v[204:207], a[216:219], v[172:175]
    buffer_store_dwordx4 v[232:235], v253, s[36:39], s58 offen offset:512 sc1
    v_mfma_f32_16x16x32_bf16 v[176:179], v[204:207], a[220:223], v[176:179]
    v_cvt_scalef32_pk_bf16_fp4 v204, v124, s75 op_sel:[0,0,0]
    v_cvt_scalef32_pk_bf16_fp4 v205, v124, s75 op_sel:[1,0,0]
    v_mfma_f32_16x16x32_bf16 v[180:183], v[208:211], a[208:211], v[180:183]
    v_cvt_scalef32_pk_bf16_fp4 v206, v124, s75 op_sel:[0,1,0]
    v_cvt_scalef32_pk_bf16_fp4 v207, v124, s75 op_sel:[1,1,0]
    v_mfma_f32_16x16x32_bf16 v[184:187], v[208:211], a[212:215], v[184:187]
    ds_read_b128 v[236:239], v254 offset:11264
    v_mfma_f32_16x16x32_bf16 v[188:191], v[208:211], a[216:219], v[188:191]
    v_mfma_f32_16x16x32_bf16 v[192:195], v[208:211], a[220:223], v[192:195]
    v_cvt_scalef32_pk_bf16_fp4 v208, v128, s75 op_sel:[0,0,0]
    v_cvt_scalef32_pk_bf16_fp4 v209, v128, s75 op_sel:[1,0,0]
    v_mfma_f32_16x16x32_bf16 v[164:167], v[196:199], a[224:227], v[164:167]
    s_waitcnt vmcnt(6)
    v_xad_u32 v249, v39, s53, 0
    v_mfma_f32_16x16x32_bf16 v[168:171], v[196:199], a[228:231], v[168:171]
    v_xad_u32 v249, v43, s53, v249
    v_xad_u32 v249, v47, s53, v249
    v_mfma_f32_16x16x32_bf16 v[172:175], v[196:199], a[232:235], v[172:175]
    v_xad_u32 v249, v51, s53, v249
    v_cvt_scalef32_pk_bf16_fp4 v210, v128, s75 op_sel:[0,1,0]
    v_mfma_f32_16x16x32_bf16 v[176:179], v[196:199], a[236:239], v[176:179]
    v_cvt_scalef32_pk_bf16_fp4 v211, v128, s75 op_sel:[1,1,0]
    v_xad_u32 v249, v55, s53, v249
    v_mfma_f32_16x16x32_bf16 v[180:183], v[200:203], a[224:227], v[180:183]
    v_cvt_scalef32_pk_bf16_fp4 v196, v125, s75 op_sel:[0,0,0]
    v_cvt_scalef32_pk_bf16_fp4 v197, v125, s75 op_sel:[1,0,0]
    v_mfma_f32_16x16x32_bf16 v[184:187], v[200:203], a[228:231], v[184:187]
    v_xad_u32 v249, v59, s53, v249
    v_cvt_scalef32_pk_bf16_fp4 v198, v125, s75 op_sel:[0,1,0]
    v_mfma_f32_16x16x32_bf16 v[188:191], v[200:203], a[232:235], v[188:191]
    v_cvt_scalef32_pk_bf16_fp4 v199, v125, s75 op_sel:[1,1,0]
    v_cmp_ne_u32 vcc, 0, v249
    v_mfma_f32_16x16x32_bf16 v[192:195], v[200:203], a[236:239], v[192:195]
    v_cvt_scalef32_pk_bf16_fp4 v200, v129, s75 op_sel:[0,0,0]
    v_cvt_scalef32_pk_bf16_fp4 v201, v129, s75 op_sel:[1,0,0]
    v_mfma_f32_16x16x32_bf16 v[164:167], v[204:207], a[240:243], v[164:167]
    v_cvt_scalef32_pk_bf16_fp4 v202, v129, s75 op_sel:[0,1,0]
    v_cvt_scalef32_pk_bf16_fp4 v203, v129, s75 op_sel:[1,1,0]
    v_mfma_f32_16x16x32_bf16 v[168:171], v[204:207], a[244:247], v[168:171]
    s_waitcnt lgkmcnt(0)
    s_cbranch_vccnz K_retry4
K_back4:
    v_mfma_f32_16x16x32_bf16 v[172:175], v[204:207], a[248:251], v[172:175]
    buffer_store_dwordx4 v[236:239], v253, s[36:39], s59 offen offset:512 sc1
    v_mfma_f32_16x16x32_bf16 v[176:179], v[204:207], a[252:255], v[176:179]
    v_cvt_scalef32_pk_bf16_fp4 v204, v126, s75 op_sel:[0,0,0]
    v_cvt_scalef32_pk_bf16_fp4 v205, v126, s75 op_sel:[1,0,0]
    v_mfma_f32_16x16x32_bf16 v[180:183], v[208:211], a[240:243], v[180:183]
    v_cvt_scalef32_pk_bf16_fp4 v206, v126, s75 op_sel:[0,1,0]
    v_cvt_scalef32_pk_bf16_fp4 v207, v126, s75 op_sel:[1,1,0]
    v_mfma_f32_16x16x32_bf16 v[184:187], v[208:211], a[244:247], v[184:187]
    v_mfma_f32_16x16x32_bf16 v[188:191], v[208:211], a[248:251], v[188:191]
    v_mfma_f32_16x16x32_bf16 v[192:195], v[208:211], a[252:255], v[192:195]
    v_cvt_scalef32_pk_bf16_fp4 v208, v130, s75 op_sel:[0,0,0]
    v_cvt_scalef32_pk_bf16_fp4 v209, v130, s75 op_sel:[1,0,0]
    v_mfma_f32_16x16x32_bf16 v[164:167], v[196:199], v[4:7], v[164:167]
    v_cvt_scalef32_pk_bf16_fp4 v210, v130, s75 op_sel:[0,1,0]
    v_cvt_scalef32_pk_bf16_fp4 v211, v130, s75 op_sel:[1,1,0]
    v_mfma_f32_16x16x32_bf16 v[168:171], v[196:199], v[8:11], v[168:171]
    v_mfma_f32_16x16x32_bf16 v[172:175], v[196:199], v[12:15], v[172:175]
    v_mfma_f32_16x16x32_bf16 v[176:179], v[196:199], v[16:19], v[176:179]
    v_cvt_scalef32_pk_bf16_fp4 v196, v36, s75 op_sel:[0,0,0]
    v_cvt_scalef32_pk_bf16_fp4 v197, v36, s75 op_sel:[1,0,0]
    v_mfma_f32_16x16x32_bf16 v[180:183], v[200:203], v[4:7], v[180:183]
    v_cvt_scalef32_pk_bf16_fp4 v198, v36, s75 op_sel:[0,1,0]
    v_cvt_scalef32_pk_bf16_fp4 v199, v36, s75 op_sel:[1,1,0]
    v_mfma_f32_16x16x32_bf16 v[184:187], v[200:203], v[8:11], v[184:187]
    v_mfma_f32_16x16x32_bf16 v[188:191], v[200:203], v[12:15], v[188:191]
    v_mfma_f32_16x16x32_bf16 v[192:195], v[200:203], v[16:19], v[192:195]
    v_mfma_f32_16x16x32_bf16 v[164:167], v[204:207], v[20:23], v[164:167]
    v_mfma_f32_16x16x32_bf16 v[168:171], v[204:207], v[24:27], v[168:171]
    v_mfma_f32_16x16x32_bf16 v[172:175], v[204:207], v[28:31], v[172:175]
    v_mfma_f32_16x16x32_bf16 v[176:179], v[204:207], v[32:35], v[176:179]
    v_cvt_scalef32_pk_bf16_fp4 v204, v37, s75 op_sel:[0,0,0]
    v_cvt_scalef32_pk_bf16_fp4 v205, v37, s75 op_sel:[1,0,0]
    v_mfma_f32_16x16x32_bf16 v[180:183], v[208:211], v[20:23], v[180:183]
    v_cvt_scalef32_pk_bf16_fp4 v206, v37, s75 op_sel:[0,1,0]
    v_cvt_scalef32_pk_bf16_fp4 v207, v37, s75 op_sel:[1,1,0]
    v_mfma_f32_16x16x32_bf16 v[184:187], v[208:211], v[24:27], v[184:187]
    v_mfma_f32_16x16x32_bf16 v[188:191], v[208:211], v[28:31], v[188:191]
    v_mfma_f32_16x16x32_bf16 v[192:195], v[208:211], v[32:35], v[192:195]
    v_mfma_f32_16x16x32_bf16 v[132:135], v[196:199], a[0:3], 0
    v_lshlrev_b32 v216, 16, v212
    v_and_b32 v220, 0xffff0000, v212
    v_mfma_f32_16x16x32_bf16 v[136:139], v[196:199], a[4:7], 0
    v_lshlrev_b32 v217, 16, v213
    v_and_b32 v221, 0xffff0000, v213
    v_mfma_f32_16x16x32_bf16 v[140:143], v[196:199], a[8:11], 0
    buffer_atomic_add v2, v1, s[40:43], 0 offen sc1
    v_mfma_f32_16x16x32_bf16 v[144:147], v[196:199], a[12:15], 0
    v_cvt_scalef32_pk_bf16_fp4 v196, v38, s75 op_sel:[0,0,0]
    v_cvt_scalef32_pk_bf16_fp4 v197, v38, s75 op_sel:[1,0,0]
    v_mfma_f32_16x16x32_bf16 v[132:135], v[204:207], a[16:19], v[132:135]
    v_cvt_scalef32_pk_bf16_fp4 v198, v38, s75 op_sel:[0,1,0]
    v_cvt_scalef32_pk_bf16_fp4 v199, v38, s75 op_sel:[1,1,0]
    v_mfma_f32_16x16x32_bf16 v[136:139], v[204:207], a[20:23], v[136:139]
    v_lshlrev_b32 v218, 16, v214
    v_and_b32 v222, 0xffff0000, v214
    v_mfma_f32_16x16x32_bf16 v[140:143], v[204:207], a[24:27], v[140:143]
    v_lshlrev_b32 v219, 16, v215
    v_and_b32 v223, 0xffff0000, v215
    v_mul_f32 v164, v164, v216
    v_mfma_f32_16x16x32_bf16 v[144:147], v[204:207], a[28:31], v[144:147]
    v_mul_f32 v180, v180, v220
    v_mul_f32 v165, v165, v217
    v_mfma_f32_16x16x32_bf16 v[132:135], v[196:199], a[32:35], v[132:135]
    v_cvt_scalef32_pk_bf16_fp4 v204, v40, s75 op_sel:[0,0,0]
    v_cvt_scalef32_pk_bf16_fp4 v205, v40, s75 op_sel:[1,0,0]
    v_mfma_f32_16x16x32_bf16 v[136:139], v[196:199], a[36:39], v[136:139]
    v_mul_f32 v181, v181, v221
    v_cvt_scalef32_pk_bf16_fp4 v206, v40, s75 op_sel:[0,1,0]
    v_cvt_scalef32_pk_bf16_fp4 v207, v40, s75 op_sel:[1,1,0]
    v_mfma_f32_16x16x32_bf16 v[140:143], v[196:199], a[40:43], v[140:143]
    v_mul_f32 v166, v166, v218
    v_mul_f32 v182, v182, v222
    v_mfma_f32_16x16x32_bf16 v[144:147], v[196:199], a[44:47], v[144:147]
    v_mul_f32 v167, v167, v219
    v_cvt_scalef32_pk_bf16_fp4 v196, v41, s75 op_sel:[0,0,0]
    v_mfma_f32_16x16x32_bf16 v[132:135], v[204:207], a[48:51], v[132:135]
    v_cvt_scalef32_pk_bf16_fp4 v197, v41, s75 op_sel:[1,0,0]
    v_mul_f32 v183, v183, v223
    v_mfma_f32_16x16x32_bf16 v[136:139], v[204:207], a[52:55], v[136:139]
    v_cvt_scalef32_pk_bf16_fp4 v198, v41, s75 op_sel:[0,1,0]
    v_cvt_scalef32_pk_bf16_fp4 v199, v41, s75 op_sel:[1,1,0]
    v_mfma_f32_16x16x32_bf16 v[140:143], v[204:207], a[56:59], v[140:143]
    v_cvt_pk_bf16_f32 v224, v164, v180
    v_cvt_pk_bf16_f32 v225, v165, v181
    v_mfma_f32_16x16x32_bf16 v[144:147], v[204:207], a[60:63], v[144:147]
    v_cvt_pk_bf16_f32 v226, v166, v182
    v_cvt_scalef32_pk_bf16_fp4 v204, v42, s75 op_sel:[0,0,0]
    v_mfma_f32_16x16x32_bf16 v[132:135], v[196:199], a[64:67], v[132:135]
    v_cvt_scalef32_pk_bf16_fp4 v205, v42, s75 op_sel:[1,0,0]
    v_cvt_pk_bf16_f32 v227, v167, v183
    v_mfma_f32_16x16x32_bf16 v[136:139], v[196:199], a[68:71], v[136:139]
    v_cvt_scalef32_pk_bf16_fp4 v206, v42, s75 op_sel:[0,1,0]
    v_cvt_scalef32_pk_bf16_fp4 v207, v42, s75 op_sel:[1,1,0]
    v_mfma_f32_16x16x32_bf16 v[140:143], v[196:199], a[72:75], v[140:143]
    ds_write_b128 v245, v[224:227] offset:4096
    v_mfma_f32_16x16x32_bf16 v[144:147], v[196:199], a[76:79], v[144:147]
    v_mul_f32 v168, v168, v216
    v_mul_f32 v184, v184, v220
    v_mfma_f32_16x16x32_bf16 v[132:135], v[204:207], a[80:83], v[132:135]
    v_cvt_scalef32_pk_bf16_fp4 v196, v44, s75 op_sel:[0,0,0]
    v_cvt_scalef32_pk_bf16_fp4 v197, v44, s75 op_sel:[1,0,0]
    v_mfma_f32_16x16x32_bf16 v[136:139], v[204:207], a[84:87], v[136:139]
    v_mul_f32 v169, v169, v217
    v_cvt_scalef32_pk_bf16_fp4 v198, v44, s75 op_sel:[0,1,0]
    v_cvt_scalef32_pk_bf16_fp4 v199, v44, s75 op_sel:[1,1,0]
    v_mfma_f32_16x16x32_bf16 v[140:143], v[204:207], a[88:91], v[140:143]
    v_mul_f32 v185, v185, v221
    v_mul_f32 v170, v170, v218
    v_mfma_f32_16x16x32_bf16 v[144:147], v[204:207], a[92:95], v[144:147]
    v_mul_f32 v186, v186, v222
    v_cvt_scalef32_pk_bf16_fp4 v204, v45, s75 op_sel:[0,0,0]
    v_mfma_f32_16x16x32_bf16 v[132:135], v[196:199], a[96:99], v[132:135]
    v_cvt_scalef32_pk_bf16_fp4 v205, v45, s75 op_sel:[1,0,0]
    v_mul_f32 v171, v171, v219
    v_mfma_f32_16x16x32_bf16 v[136:139], v[196:199], a[100:103], v[136:139]
    v_cvt_scalef32_pk_bf16_fp4 v206, v45, s75 op_sel:[0,1,0]
    v_cvt_scalef32_pk_bf16_fp4 v207, v45, s75 op_sel:[1,1,0]
    v_mfma_f32_16x16x32_bf16 v[140:143], v[196:199], a[104:107], v[140:143]
    v_mul_f32 v187, v187, v223
    s_mov_b32 s51, s68
    v_mfma_f32_16x16x32_bf16 v[144:147], v[196:199], a[108:111], v[144:147]
    v_cvt_pk_bf16_f32 v228, v168, v184
    v_cvt_pk_bf16_f32 v229, v169, v185
    v_mfma_f32_16x16x32_bf16 v[132:135], v[204:207], a[112:115], v[132:135]
    v_cvt_scalef32_pk_bf16_fp4 v196, v46, s75 op_sel:[0,0,0]
    v_cvt_scalef32_pk_bf16_fp4 v197, v46, s75 op_sel:[1,0,0]
    v_mfma_f32_16x16x32_bf16 v[136:139], v[204:207], a[116:119], v[136:139]
    v_cvt_pk_bf16_f32 v230, v170, v186
    v_cvt_scalef32_pk_bf16_fp4 v198, v46, s75 op_sel:[0,1,0]
    v_cvt_scalef32_pk_bf16_fp4 v199, v46, s75 op_sel:[1,1,0]
    v_mfma_f32_16x16x32_bf16 v[140:143], v[204:207], a[120:123], v[140:143]
    v_cvt_pk_bf16_f32 v231, v171, v187
    v_mul_f32 v172, v172, v216
    v_mfma_f32_16x16x32_bf16 v[144:147], v[204:207], a[124:127], v[144:147]
    buffer_load_dwordx2 v[212:213], v242, s[28:31], s51 offen
    ds_write_b128 v245, v[228:231] offset:5120
    v_mfma_f32_16x16x32_bf16 v[132:135], v[196:199], a[128:131], v[132:135]
    v_mul_f32 v188, v188, v220
    v_cvt_scalef32_pk_bf16_fp4 v204, v48, s75 op_sel:[0,0,0]
    ds_read_b128 v[232:235], v254 offset:12288
    v_cvt_scalef32_pk_bf16_fp4 v205, v48, s75 op_sel:[1,0,0]
    v_mfma_f32_16x16x32_bf16 v[136:139], v[196:199], a[132:135], v[136:139]
    v_mul_f32 v173, v173, v217
    v_cvt_scalef32_pk_bf16_fp4 v206, v48, s75 op_sel:[0,1,0]
    v_cvt_scalef32_pk_bf16_fp4 v207, v48, s75 op_sel:[1,1,0]
    v_mfma_f32_16x16x32_bf16 v[140:143], v[196:199], a[136:139], v[140:143]
    v_mul_f32 v189, v189, v221
    v_mul_f32 v174, v174, v218
    v_mfma_f32_16x16x32_bf16 v[144:147], v[196:199], a[140:143], v[144:147]
    v_mul_f32 v190, v190, v222
    v_cvt_scalef32_pk_bf16_fp4 v196, v49, s75 op_sel:[0,0,0]
    v_mfma_f32_16x16x32_bf16 v[132:135], v[204:207], a[144:147], v[132:135]
    v_cvt_scalef32_pk_bf16_fp4 v197, v49, s75 op_sel:[1,0,0]
    v_mul_f32 v175, v175, v219
    v_mfma_f32_16x16x32_bf16 v[136:139], v[204:207], a[148:151], v[136:139]
    v_cvt_scalef32_pk_bf16_fp4 v198, v49, s75 op_sel:[0,1,0]
    v_cvt_scalef32_pk_bf16_fp4 v199, v49, s75 op_sel:[1,1,0]
    v_mfma_f32_16x16x32_bf16 v[140:143], v[204:207], a[152:155], v[140:143]
    v_mul_f32 v191, v191, v223
    s_waitcnt lgkmcnt(0)
    v_mfma_f32_16x16x32_bf16 v[144:147], v[204:207], a[156:159], v[144:147]
    v_cvt_pk_bf16_f32 v224, v172, v188
    v_cvt_pk_bf16_f32 v225, v173, v189
    buffer_store_dwordx4 v[232:235], v253, s[36:39], s56 offen offset:576 sc1
    v_mfma_f32_16x16x32_bf16 v[132:135], v[196:199], a[160:163], v[132:135]
    ds_read_b128 v[236:239], v254 offset:13312
    v_cvt_scalef32_pk_bf16_fp4 v204, v50, s75 op_sel:[0,0,0]
    v_cvt_scalef32_pk_bf16_fp4 v205, v50, s75 op_sel:[1,0,0]
    v_mfma_f32_16x16x32_bf16 v[136:139], v[196:199], a[164:167], v[136:139]
    v_cvt_pk_bf16_f32 v226, v174, v190
    v_cvt_scalef32_pk_bf16_fp4 v206, v50, s75 op_sel:[0,1,0]
    v_cvt_scalef32_pk_bf16_fp4 v207, v50, s75 op_sel:[1,1,0]
    v_mfma_f32_16x16x32_bf16 v[140:143], v[196:199], a[168:171], v[140:143]
    v_cvt_pk_bf16_f32 v227, v175, v191
    v_mul_f32 v176, v176, v216
    v_mfma_f32_16x16x32_bf16 v[144:147], v[196:199], a[172:175], v[144:147]
    ds_write_b128 v245, v[224:227] offset:6144
    v_mfma_f32_16x16x32_bf16 v[132:135], v[204:207], a[176:179], v[132:135]
    v_cvt_scalef32_pk_bf16_fp4 v196, v52, s75 op_sel:[0,0,0]
    v_cvt_scalef32_pk_bf16_fp4 v197, v52, s75 op_sel:[1,0,0]
    v_mfma_f32_16x16x32_bf16 v[136:139], v[204:207], a[180:183], v[136:139]
    v_mul_f32 v192, v192, v220
    v_cvt_scalef32_pk_bf16_fp4 v198, v52, s75 op_sel:[0,1,0]
    v_cvt_scalef32_pk_bf16_fp4 v199, v52, s75 op_sel:[1,1,0]
    v_mfma_f32_16x16x32_bf16 v[140:143], v[204:207], a[184:187], v[140:143]
    v_mul_f32 v177, v177, v217
    s_waitcnt lgkmcnt(1)
    v_mfma_f32_16x16x32_bf16 v[144:147], v[204:207], a[188:191], v[144:147]
    v_mul_f32 v193, v193, v221
    v_mul_f32 v178, v178, v218
    buffer_store_dwordx4 v[236:239], v253, s[36:39], s57 offen offset:576 sc1
    v_mfma_f32_16x16x32_bf16 v[132:135], v[196:199], a[192:195], v[132:135]
    ds_read_b128 v[232:235], v254 offset:14336
    v_cvt_scalef32_pk_bf16_fp4 v204, v53, s75 op_sel:[0,0,0]
    v_cvt_scalef32_pk_bf16_fp4 v205, v53, s75 op_sel:[1,0,0]
    v_mfma_f32_16x16x32_bf16 v[136:139], v[196:199], a[196:199], v[136:139]
    v_mul_f32 v194, v194, v222
    v_cvt_scalef32_pk_bf16_fp4 v206, v53, s75 op_sel:[0,1,0]
    v_cvt_scalef32_pk_bf16_fp4 v207, v53, s75 op_sel:[1,1,0]
    v_mfma_f32_16x16x32_bf16 v[140:143], v[196:199], a[200:203], v[140:143]
    v_mul_f32 v179, v179, v219
    v_mul_f32 v195, v195, v223
    v_mfma_f32_16x16x32_bf16 v[144:147], v[196:199], a[204:207], v[144:147]
    v_cvt_pk_bf16_f32 v228, v176, v192
    v_cvt_scalef32_pk_bf16_fp4 v196, v54, s75 op_sel:[0,0,0]
    v_mfma_f32_16x16x32_bf16 v[132:135], v[204:207], a[208:211], v[132:135]
    v_cvt_scalef32_pk_bf16_fp4 v197, v54, s75 op_sel:[1,0,0]
    v_cvt_pk_bf16_f32 v229, v177, v193
    v_mfma_f32_16x16x32_bf16 v[136:139], v[204:207], a[212:215], v[136:139]
    v_cvt_scalef32_pk_bf16_fp4 v198, v54, s75 op_sel:[0,1,0]
    v_cvt_scalef32_pk_bf16_fp4 v199, v54, s75 op_sel:[1,1,0]
    v_mfma_f32_16x16x32_bf16 v[140:143], v[204:207], a[216:219], v[140:143]
    v_cvt_pk_bf16_f32 v230, v178, v194
    s_waitcnt lgkmcnt(0)
    v_mfma_f32_16x16x32_bf16 v[144:147], v[204:207], a[220:223], v[144:147]
    v_cvt_pk_bf16_f32 v231, v179, v195
    v_cvt_scalef32_pk_bf16_fp4 v204, v56, s75 op_sel:[0,0,0]
    buffer_store_dwordx4 v[232:235], v253, s[36:39], s58 offen offset:576 sc1
    v_mfma_f32_16x16x32_bf16 v[132:135], v[196:199], a[224:227], v[132:135]
    ds_write_b128 v245, v[228:231] offset:7168
    v_cvt_scalef32_pk_bf16_fp4 v205, v56, s75 op_sel:[1,0,0]
    v_mfma_f32_16x16x32_bf16 v[136:139], v[196:199], a[228:231], v[136:139]
    ds_read_b128 v[236:239], v254 offset:15360
    v_cvt_scalef32_pk_bf16_fp4 v206, v56, s75 op_sel:[0,1,0]
    v_cvt_scalef32_pk_bf16_fp4 v207, v56, s75 op_sel:[1,1,0]
    v_mfma_f32_16x16x32_bf16 v[140:143], v[196:199], a[232:235], v[140:143]
    s_waitcnt vmcnt(3)
    v_lshlrev_b32 v216, 16, v212
    v_mfma_f32_16x16x32_bf16 v[144:147], v[196:199], a[236:239], v[144:147]
    v_cvt_scalef32_pk_bf16_fp4 v196, v57, s75 op_sel:[0,0,0]
    v_cvt_scalef32_pk_bf16_fp4 v197, v57, s75 op_sel:[1,0,0]
    v_mfma_f32_16x16x32_bf16 v[132:135], v[204:207], a[240:243], v[132:135]
    v_cvt_scalef32_pk_bf16_fp4 v198, v57, s75 op_sel:[0,1,0]
    v_cvt_scalef32_pk_bf16_fp4 v199, v57, s75 op_sel:[1,1,0]
    v_mfma_f32_16x16x32_bf16 v[136:139], v[204:207], a[244:247], v[136:139]
    v_and_b32 v217, 0xffff0000, v212
    v_lshlrev_b32 v218, 16, v213
    v_mfma_f32_16x16x32_bf16 v[140:143], v[204:207], a[248:251], v[140:143]
    s_waitcnt lgkmcnt(0)
    v_and_b32 v219, 0xffff0000, v213
    v_mfma_f32_16x16x32_bf16 v[144:147], v[204:207], a[252:255], v[144:147]
    buffer_store_dwordx4 v[236:239], v253, s[36:39], s59 offen offset:576 sc1
    v_mfma_f32_16x16x32_bf16 v[132:135], v[196:199], v[4:7], v[132:135]
    v_cvt_scalef32_pk_bf16_fp4 v204, v58, s75 op_sel:[0,0,0]
    v_cvt_scalef32_pk_bf16_fp4 v205, v58, s75 op_sel:[1,0,0]
    v_mfma_f32_16x16x32_bf16 v[136:139], v[196:199], v[8:11], v[136:139]
    v_cvt_scalef32_pk_bf16_fp4 v206, v58, s75 op_sel:[0,1,0]
    v_cvt_scalef32_pk_bf16_fp4 v207, v58, s75 op_sel:[1,1,0]
    v_mfma_f32_16x16x32_bf16 v[140:143], v[196:199], v[12:15], v[140:143]
    v_mfma_f32_16x16x32_bf16 v[144:147], v[196:199], v[16:19], v[144:147]
    v_mfma_f32_16x16x32_bf16 v[132:135], v[204:207], v[20:23], v[132:135]
    v_mfma_f32_16x16x32_bf16 v[136:139], v[204:207], v[24:27], v[136:139]
    v_mfma_f32_16x16x32_bf16 v[140:143], v[204:207], v[28:31], v[140:143]
    v_mfma_f32_16x16x32_bf16 v[144:147], v[204:207], v[32:35], v[144:147]
    s_nop 4
    v_mul_f32 v132, v132, v216
    v_mul_f32 v133, v133, v217
    v_mul_f32 v134, v134, v218
    v_mul_f32 v135, v135, v219
    v_cvt_pk_bf16_f32 v224, v132, v133
    v_cvt_pk_bf16_f32 v225, v134, v135
    ds_write_b64 v243, v[224:225] offset:0
    v_mul_f32 v136, v136, v216
    v_mul_f32 v137, v137, v217
    v_mul_f32 v138, v138, v218
    v_mul_f32 v139, v139, v219
    v_cvt_pk_bf16_f32 v228, v136, v137
    v_cvt_pk_bf16_f32 v229, v138, v139
    ds_write_b64 v243, v[228:229] offset:2048
    v_mul_f32 v140, v140, v216
    v_mul_f32 v141, v141, v217
    v_mul_f32 v142, v142, v218
    v_mul_f32 v143, v143, v219
    v_cvt_pk_bf16_f32 v224, v140, v141
    v_cvt_pk_bf16_f32 v225, v142, v143
    ds_write_b64 v243, v[224:225] offset:4096
    v_mul_f32 v144, v144, v216
    v_mul_f32 v145, v145, v217
    v_mul_f32 v146, v146, v218
    v_mul_f32 v147, v147, v219
    v_cvt_pk_bf16_f32 v228, v144, v145
    v_cvt_pk_bf16_f32 v229, v146, v147
    ds_write_b64 v243, v[228:229] offset:6144
K_qbar:
    s_lshl_b32 s51, s48, 11
    s_add_u32 s51, s51, 139264
    v_add_u32 v254, s51, v244
    s_waitcnt lgkmcnt(0)
    s_barrier
    ds_read_b128 v[232:235], v254 offset:0
    ds_read_b128 v[236:239], v254 offset:1024
    s_waitcnt lgkmcnt(1)
    buffer_store_dwordx4 v[232:235], v247, s[36:39], s60 offen sc1
    s_waitcnt lgkmcnt(0)
    buffer_store_dwordx4 v[236:239], v248, s[36:39], s60 offen sc1
K_done:
    s_endpgm
K_retry1:
    s_mov_b32 s55, 0
    s_add_u32 s64, s62, 12288
    s_add_u32 s65, s62, 16384
    s_add_u32 s66, s62, 20480
K_retry1_loop:
    buffer_load_dword v3, v0, s[40:43], s64 offen sc1
    s_waitcnt vmcnt(0)
    v_cmp_ne_u32 vcc, s53, v3
    s_cbranch_vccnz K_retry1_loop_again
K_retry1_loop_full:
    buffer_load_dwordx4 v[84:87], v244, s[40:43], s64 offen sc1
    buffer_load_dwordx4 v[88:91], v244, s[40:43], s64 offen offset:1024 sc1
    buffer_load_dwordx4 v[92:95], v244, s[40:43], s64 offen offset:2048 sc1
    buffer_load_dwordx4 v[96:99], v244, s[40:43], s64 offen offset:3072 sc1
    buffer_load_dwordx4 v[100:103], v244, s[40:43], s65 offen sc1
    buffer_load_dwordx4 v[104:107], v244, s[40:43], s65 offen offset:1024 sc1
    buffer_load_dwordx4 v[108:111], v244, s[40:43], s65 offen offset:2048 sc1
    buffer_load_dwordx4 v[112:115], v244, s[40:43], s65 offen offset:3072 sc1
    buffer_load_dwordx4 v[116:119], v244, s[40:43], s66 offen sc1
    buffer_load_dwordx4 v[120:123], v244, s[40:43], s66 offen offset:1024 sc1
    buffer_load_dwordx4 v[124:127], v244, s[40:43], s66 offen offset:2048 sc1
    buffer_load_dwordx4 v[128:131], v244, s[40:43], s66 offen offset:3072 sc1
    s_waitcnt vmcnt(0)
    v_xad_u32 v249, v87, s53, 0
    v_xad_u32 v249, v91, s53, v249
    v_xad_u32 v249, v95, s53, v249
    v_xad_u32 v249, v99, s53, v249
    v_xad_u32 v249, v103, s53, v249
    v_xad_u32 v249, v107, s53, v249
    v_xad_u32 v249, v111, s53, v249
    v_xad_u32 v249, v115, s53, v249
    v_xad_u32 v249, v119, s53, v249
    v_xad_u32 v249, v123, s53, v249
    v_xad_u32 v249, v127, s53, v249
    v_xad_u32 v249, v131, s53, v249
    v_cmp_ne_u32 vcc, 0, v249
    s_cbranch_vccz K_back1
K_retry1_loop_again:
    s_add_u32 s55, s55, 1
    s_cmp_lt_u32 s55, 4096
    s_cbranch_scc1 K_retry1_loop
    s_branch K_fallback
K_retry2:
    s_mov_b32 s55, 0
    s_add_u32 s64, s62, 98304
    s_add_u32 s65, s62, 102400
    s_add_u32 s66, s62, 106496
K_retry2_loop:
    buffer_load_dword v3, v0, s[40:43], s64 offen sc1
    s_waitcnt vmcnt(0)
    v_cmp_ne_u32 vcc, s53, v3
    s_cbranch_vccnz K_retry2_loop_again
K_retry2_loop_full:
    buffer_load_dwordx4 v[36:39], v244, s[40:43], s64 offen sc1
    buffer_load_dwordx4 v[40:43], v244, s[40:43], s64 offen offset:1024 sc1
    buffer_load_dwordx4 v[44:47], v244, s[40:43], s64 offen offset:2048 sc1
    buffer_load_dwordx4 v[48:51], v244, s[40:43], s64 offen offset:3072 sc1
    buffer_load_dwordx4 v[52:55], v244, s[40:43], s65 offen sc1
    buffer_load_dwordx4 v[56:59], v244, s[40:43], s65 offen offset:1024 sc1
    buffer_load_dwordx4 v[60:63], v244, s[40:43], s65 offen offset:2048 sc1
    buffer_load_dwordx4 v[64:67], v244, s[40:43], s65 offen offset:3072 sc1
    buffer_load_dwordx4 v[68:71], v244, s[40:43], s66 offen sc1
    buffer_load_dwordx4 v[72:75], v244, s[40:43], s66 offen offset:1024 sc1
    buffer_load_dwordx4 v[76:79], v244, s[40:43], s66 offen offset:2048 sc1
    buffer_load_dwordx4 v[80:83], v244, s[40:43], s66 offen offset:3072 sc1
    s_waitcnt vmcnt(0)
    v_xad_u32 v249, v39, s53, 0
    v_xad_u32 v249, v43, s53, v249
    v_xad_u32 v249, v47, s53, v249
    v_xad_u32 v249, v51, s53, v249
    v_xad_u32 v249, v55, s53, v249
    v_xad_u32 v249, v59, s53, v249
    v_xad_u32 v249, v63, s53, v249
    v_xad_u32 v249, v67, s53, v249
    v_xad_u32 v249, v71, s53, v249
    v_xad_u32 v249, v75, s53, v249
    v_xad_u32 v249, v79, s53, v249
    v_xad_u32 v249, v83, s53, v249
    v_cmp_ne_u32 vcc, 0, v249
    s_cbranch_vccz K_back2
K_retry2_loop_again:
    s_add_u32 s55, s55, 1
    s_cmp_lt_u32 s55, 4096
    s_cbranch_scc1 K_retry2_loop
    s_branch K_fallback
K_retry3:
    s_mov_b32 s55, 0
    s_add_u32 s64, s62, 110592
    s_add_u32 s65, s62, 114688
    s_add_u32 s66, s62, 118784
K_retry3_loop:
    buffer_load_dword v3, v0, s[40:43], s64 offen sc1
    s_waitcnt vmcnt(0)
    v_cmp_ne_u32 vcc, s53, v3
    s_cbranch_vccnz K_retry3_loop_again
K_retry3_loop_full:
    buffer_load_dwordx4 v[84:87], v244, s[40:43], s64 offen sc1
    buffer_load_dwordx4 v[88:91], v244, s[40:43], s64 offen offset:1024 sc1
    buffer_load_dwordx4 v[92:95], v244, s[40:43], s64 offen offset:2048 sc1
    buffer_load_dwordx4 v[96:99], v244, s[40:43], s64 offen offset:3072 sc1
    buffer_load_dwordx4 v[100:103], v244, s[40:43], s65 offen sc1
    buffer_load_dwordx4 v[104:107], v244, s[40:43], s65 offen offset:1024 sc1
    buffer_load_dwordx4 v[108:111], v244, s[40:43], s65 offen offset:2048 sc1
    buffer_load_dwordx4 v[112:115], v244, s[40:43], s65 offen offset:3072 sc1
    buffer_load_dwordx4 v[116:119], v244, s[40:43], s66 offen sc1
    buffer_load_dwordx4 v[120:123], v244, s[40:43], s66 offen offset:1024 sc1
    buffer_load_dwordx4 v[124:127], v244, s[40:43], s66 offen offset:2048 sc1
    buffer_load_dwordx4 v[128:131], v244, s[40:43], s66 offen offset:3072 sc1
    s_waitcnt vmcnt(0)
    v_xad_u32 v249, v87, s53, 0
    v_xad_u32 v249, v91, s53, v249
    v_xad_u32 v249, v95, s53, v249
    v_xad_u32 v249, v99, s53, v249
    v_xad_u32 v249, v103, s53, v249
    v_xad_u32 v249, v107, s53, v249
    v_xad_u32 v249, v111, s53, v249
    v_xad_u32 v249, v115, s53, v249
    v_xad_u32 v249, v119, s53, v249
    v_xad_u32 v249, v123, s53, v249
    v_xad_u32 v249, v127, s53, v249
    v_xad_u32 v249, v131, s53, v249
    v_cmp_ne_u32 vcc, 0, v249
    s_cbranch_vccz K_back3
K_retry3_loop_again:
    s_add_u32 s55, s55, 1
    s_cmp_lt_u32 s55, 4096
    s_cbranch_scc1 K_retry3_loop
    s_branch K_fallback
K_retry4:
    s_mov_b32 s55, 0
    s_add_u32 s64, s63, 0
    s_add_u32 s65, s63, 4096
K_retry4_loop:
    buffer_load_dword v3, v0, s[40:43], s61 offen sc1
    s_waitcnt vmcnt(0)
    v_cmp_ne_u32 vcc, s53, v3
    s_cbranch_vccnz K_retry4_loop_again
K_retry4_loop_full:
    buffer_load_dwordx4 v[36:39], v244, s[40:43], s64 offen sc1
    buffer_load_dwordx4 v[40:43], v244, s[40:43], s64 offen offset:1024 sc1
    buffer_load_dwordx4 v[44:47], v244, s[40:43], s64 offen offset:2048 sc1
    buffer_load_dwordx4 v[48:51], v244, s[40:43], s64 offen offset:3072 sc1
    buffer_load_dwordx4 v[52:55], v244, s[40:43], s65 offen sc1
    buffer_load_dwordx4 v[56:59], v244, s[40:43], s65 offen offset:1024 sc1
    s_waitcnt vmcnt(0)
    v_xad_u32 v249, v39, s53, 0
    v_xad_u32 v249, v43, s53, v249
    v_xad_u32 v249, v47, s53, v249
    v_xad_u32 v249, v51, s53, v249
    v_xad_u32 v249, v55, s53, v249
    v_xad_u32 v249, v59, s53, v249
    v_cmp_ne_u32 vcc, 0, v249
    s_cbranch_vccz K_back4
K_retry4_loop_again:
    s_add_u32 s55, s55, 1
    s_cmp_lt_u32 s55, 4096
    s_cbranch_scc1 K_retry4_loop
    s_branch K_fallback
K_fallback:
    s_waitcnt vmcnt(0) lgkmcnt(0)
    v_and_b32 v87, 15, v250
    v_lshrrev_b32 v88, 4, v250
    buffer_atomic_add v2, v1, s[40:43], 0 offen sc1
    v_mul_u32_u24 v84, 9216, v87
    v_add_u32 v84, v84, v246
    s_mov_b32 s64, 0
K_fb_job:
    s_lshr_b32 s51, s64, 1
    s_lshl_b32 s51, s51, 3
    s_and_b32 s52, s64, 1
    s_add_u32 s51, s51, s52
    s_lshl_b32 s52, s48, 1
    s_add_u32 s73, s51, s52
    s_lshl_b32 s51, s73, 5
    s_lshl_b32 s52, s48, 4
    s_add_u32 s52, s52, 512
    s_cmp_lt_u32 s64, 4
    s_cselect_b32 s51, s51, s52
    s_cselect_b32 s92, 3, 2
    s_mul_i32 s66, s50, 576
    s_add_u32 s66, s66, s51
    v_lshlrev_b32 v85, s92, v87
    v_lshrrev_b32 v86, 1, v85
    v_mul_u32_u24 v80, 147456, v88
    v_add_u32 v85, v85, v80
    s_lshl_b32 s51, s66, 1
    s_cmp_lt_u32 s64, 4
    s_cbranch_scc0 K_fb_zq
    buffer_load_dword v80, v86, s[32:35], s51 offen
    buffer_load_dword v81, v86, s[28:31], s51 offen
    s_branch K_fb_zok
K_fb_zq:
    buffer_load_ushort v80, v86, s[32:35], s51 offen
    buffer_load_ushort v81, v86, s[28:31], s51 offen
K_fb_zok:
    v_mov_b32 v132, 0
    v_mov_b32 v133, 0
    v_mov_b32 v134, 0
    v_mov_b32 v135, 0
    v_mov_b32 v136, 0
    v_mov_b32 v137, 0
    v_mov_b32 v138, 0
    v_mov_b32 v139, 0
    v_mov_b32 v140, 0
    v_mov_b32 v141, 0
    v_mov_b32 v142, 0
    v_mov_b32 v143, 0
    v_mov_b32 v144, 0
    v_mov_b32 v145, 0
    v_mov_b32 v146, 0
    v_mov_b32 v147, 0
    v_mov_b32 v148, 0
    v_mov_b32 v149, 0
    v_mov_b32 v150, 0
    v_mov_b32 v151, 0
    v_mov_b32 v152, 0
    v_mov_b32 v153, 0
    v_mov_b32 v154, 0
    v_mov_b32 v155, 0
    v_mov_b32 v156, 0
    v_mov_b32 v157, 0
    v_mov_b32 v158, 0
    v_mov_b32 v159, 0
    v_mov_b32 v160, 0
    v_mov_b32 v161, 0
    v_mov_b32 v162, 0
    v_mov_b32 v163, 0
    s_waitcnt vmcnt(0)
    v_lshlrev_b32 v76, 16, v80
    v_and_b32 v77, 0xffff0000, v80
    v_lshlrev_b32 v78, 16, v81
    v_and_b32 v79, 0xffff0000, v81
    s_lshl_b32 s69, s66, 2
    s_mov_b32 s65, 0
K_fb_k:
    buffer_load_dwordx2 v[36:37], v85, s[24:27], s69 offen
    s_add_u32 s69, s69, 18432
    buffer_load_dwordx2 v[38:39], v85, s[24:27], s69 offen
    s_add_u32 s69, s69, 18432
    buffer_load_dwordx2 v[40:41], v85, s[24:27], s69 offen
    s_add_u32 s69, s69, 18432
    buffer_load_dwordx2 v[42:43], v85, s[24:27], s69 offen
    s_add_u32 s69, s69, 18432
    buffer_load_dwordx2 v[44:45], v85, s[24:27], s69 offen
    s_add_u32 s69, s69, 18432
    buffer_load_dwordx2 v[46:47], v85, s[24:27], s69 offen
    s_add_u32 s69, s69, 18432
    buffer_load_dwordx2 v[48:49], v85, s[24:27], s69 offen
    s_add_u32 s69, s69, 18432
    buffer_load_dwordx2 v[50:51], v85, s[24:27], s69 offen
    s_add_u32 s69, s69, 460800
    s_lshr_b32 s51, s65, 1
    s_lshl_b32 s51, s51, 7
    s_and_b32 s52, s65, 1
    s_lshl_b32 s52, s52, 6
    v_add_u32 v80, s51, v240
    v_xor_b32 v80, s52, v80
    ds_read_b128 v[60:63], v80 offset:0
    ds_read_b128 v[64:67], v80 offset:18432
    ds_read_b128 v[68:71], v80 offset:36864
    ds_read_b128 v[72:75], v80 offset:55296
    s_waitcnt vmcnt(0)
    v_cvt_f32_i32 v82, v36
    v_cvt_f32_i32 v83, v38
    v_cvt_pk_bf16_f32 v83, v82, v83
    v_lshlrev_b32 v82, 16, v83
    v_and_b32 v83, 0xffff0000, v83
    v_sub_f32 v82, v82, v76
    v_sub_f32 v83, v83, v76
    v_cvt_pk_bf16_f32 v83, v82, v83
    v_lshlrev_b32 v82, 16, v83
    v_and_b32 v83, 0xffff0000, v83
    v_mul_f32 v82, v82, v78
    v_mul_f32 v83, v83, v78
    v_cvt_pk_bf16_f32 v52, v82, v83
    v_cvt_f32_i32 v82, v40
    v_cvt_f32_i32 v83, v42
    v_cvt_pk_bf16_f32 v83, v82, v83
    v_lshlrev_b32 v82, 16, v83
    v_and_b32 v83, 0xffff0000, v83
    v_sub_f32 v82, v82, v76
    v_sub_f32 v83, v83, v76
    v_cvt_pk_bf16_f32 v83, v82, v83
    v_lshlrev_b32 v82, 16, v83
    v_and_b32 v83, 0xffff0000, v83
    v_mul_f32 v82, v82, v78
    v_mul_f32 v83, v83, v78
    v_cvt_pk_bf16_f32 v53, v82, v83
    v_cvt_f32_i32 v82, v44
    v_cvt_f32_i32 v83, v46
    v_cvt_pk_bf16_f32 v83, v82, v83
    v_lshlrev_b32 v82, 16, v83
    v_and_b32 v83, 0xffff0000, v83
    v_sub_f32 v82, v82, v76
    v_sub_f32 v83, v83, v76
    v_cvt_pk_bf16_f32 v83, v82, v83
    v_lshlrev_b32 v82, 16, v83
    v_and_b32 v83, 0xffff0000, v83
    v_mul_f32 v82, v82, v78
    v_mul_f32 v83, v83, v78
    v_cvt_pk_bf16_f32 v54, v82, v83
    v_cvt_f32_i32 v82, v48
    v_cvt_f32_i32 v83, v50
    v_cvt_pk_bf16_f32 v83, v82, v83
    v_lshlrev_b32 v82, 16, v83
    v_and_b32 v83, 0xffff0000, v83
    v_sub_f32 v82, v82, v76
    v_sub_f32 v83, v83, v76
    v_cvt_pk_bf16_f32 v83, v82, v83
    v_lshlrev_b32 v82, 16, v83
    v_and_b32 v83, 0xffff0000, v83
    v_mul_f32 v82, v82, v78
    v_mul_f32 v83, v83, v78
    v_cvt_pk_bf16_f32 v55, v82, v83
    v_cvt_f32_i32 v82, v37
    v_cvt_f32_i32 v83, v39
    v_cvt_pk_bf16_f32 v83, v82, v83
    v_lshlrev_b32 v82, 16, v83
    v_and_b32 v83, 0xffff0000, v83
    v_sub_f32 v82, v82, v77
    v_sub_f32 v83, v83, v77
    v_cvt_pk_bf16_f32 v83, v82, v83
    v_lshlrev_b32 v82, 16, v83
    v_and_b32 v83, 0xffff0000, v83
    v_mul_f32 v82, v82, v79
    v_mul_f32 v83, v83, v79
    v_cvt_pk_bf16_f32 v56, v82, v83
    v_cvt_f32_i32 v82, v41
    v_cvt_f32_i32 v83, v43
    v_cvt_pk_bf16_f32 v83, v82, v83
    v_lshlrev_b32 v82, 16, v83
    v_and_b32 v83, 0xffff0000, v83
    v_sub_f32 v82, v82, v77
    v_sub_f32 v83, v83, v77
    v_cvt_pk_bf16_f32 v83, v82, v83
    v_lshlrev_b32 v82, 16, v83
    v_and_b32 v83, 0xffff0000, v83
    v_mul_f32 v82, v82, v79
    v_mul_f32 v83, v83, v79
    v_cvt_pk_bf16_f32 v57, v82, v83
    v_cvt_f32_i32 v82, v45
    v_cvt_f32_i32 v83, v47
    v_cvt_pk_bf16_f32 v83, v82, v83
    v_lshlrev_b32 v82, 16, v83
    v_and_b32 v83, 0xffff0000, v83
    v_sub_f32 v82, v82, v77
    v_sub_f32 v83, v83, v77
    v_cvt_pk_bf16_f32 v83, v82, v83
    v_lshlrev_b32 v82, 16, v83
    v_and_b32 v83, 0xffff0000, v83
    v_mul_f32 v82, v82, v79
    v_mul_f32 v83, v83, v79
    v_cvt_pk_bf16_f32 v58, v82, v83
    v_cvt_f32_i32 v82, v49
    v_cvt_f32_i32 v83, v51
    v_cvt_pk_bf16_f32 v83, v82, v83
    v_lshlrev_b32 v82, 16, v83
    v_and_b32 v83, 0xffff0000, v83
    v_sub_f32 v82, v82, v77
    v_sub_f32 v83, v83, v77
    v_cvt_pk_bf16_f32 v83, v82, v83
    v_lshlrev_b32 v82, 16, v83
    v_and_b32 v83, 0xffff0000, v83
    v_mul_f32 v82, v82, v79
    v_mul_f32 v83, v83, v79
    v_cvt_pk_bf16_f32 v59, v82, v83
    s_waitcnt lgkmcnt(0)
    s_nop 1
    v_mfma_f32_16x16x32_bf16 v[132:135], v[52:55], v[60:63], v[132:135]
    v_mfma_f32_16x16x32_bf16 v[136:139], v[52:55], v[64:67], v[136:139]
    v_mfma_f32_16x16x32_bf16 v[140:143], v[52:55], v[68:71], v[140:143]
    v_mfma_f32_16x16x32_bf16 v[144:147], v[52:55], v[72:75], v[144:147]
    v_mfma_f32_16x16x32_bf16 v[148:151], v[56:59], v[60:63], v[148:151]
    v_mfma_f32_16x16x32_bf16 v[152:155], v[56:59], v[64:67], v[152:155]
    v_mfma_f32_16x16x32_bf16 v[156:159], v[56:59], v[68:71], v[156:159]
    v_mfma_f32_16x16x32_bf16 v[160:163], v[56:59], v[72:75], v[160:163]
    s_add_u32 s65, s65, 1
    s_cmp_lt_u32 s65, 18
    s_cbranch_scc1 K_fb_k
    s_nop 7
    s_nop 1
    s_cmp_lt_u32 s64, 4
    s_cbranch_scc0 K_fb_quad
    s_lshl_b32 s51, s73, 6
    v_cvt_pk_bf16_f32 v224, v132, v148
    v_cvt_pk_bf16_f32 v225, v133, v149
    v_cvt_pk_bf16_f32 v226, v134, v150
    v_cvt_pk_bf16_f32 v227, v135, v151
    s_add_u32 s52, s56, s51
    buffer_store_dwordx4 v[224:227], v84, s[36:39], s52 offen
    v_cvt_pk_bf16_f32 v228, v136, v152
    v_cvt_pk_bf16_f32 v229, v137, v153
    v_cvt_pk_bf16_f32 v230, v138, v154
    v_cvt_pk_bf16_f32 v231, v139, v155
    s_add_u32 s52, s57, s51
    buffer_store_dwordx4 v[228:231], v84, s[36:39], s52 offen
    v_cvt_pk_bf16_f32 v224, v140, v156
    v_cvt_pk_bf16_f32 v225, v141, v157
    v_cvt_pk_bf16_f32 v226, v142, v158
    v_cvt_pk_bf16_f32 v227, v143, v159
    s_add_u32 s52, s58, s51
    buffer_store_dwordx4 v[224:227], v84, s[36:39], s52 offen
    v_cvt_pk_bf16_f32 v228, v144, v160
    v_cvt_pk_bf16_f32 v229, v145, v161
    v_cvt_pk_bf16_f32 v230, v146, v162
    v_cvt_pk_bf16_f32 v231, v147, v163
    s_add_u32 s52, s59, s51
    buffer_store_dwordx4 v[228:231], v84, s[36:39], s52 offen
    s_waitcnt vmcnt(0)
    s_add_u32 s64, s64, 1
    s_branch K_fb_job
K_fb_quad:
    v_cvt_pk_bf16_f32 v224, v132, v133
    v_cvt_pk_bf16_f32 v225, v134, v135
    ds_write_b64 v243, v[224:225] offset:0
    v_cvt_pk_bf16_f32 v228, v136, v137
    v_cvt_pk_bf16_f32 v229, v138, v139
    ds_write_b64 v243, v[228:229] offset:2048
    v_cvt_pk_bf16_f32 v224, v140, v141
    v_cvt_pk_bf16_f32 v225, v142, v143
    ds_write_b64 v243, v[224:225] offset:4096
    v_cvt_pk_bf16_f32 v228, v144, v145
    v_cvt_pk_bf16_f32 v229, v146, v147
    ds_write_b64 v243, v[228:229] offset:6144
    s_branch K_qbar
K_end:
    s_nop 0
.section .rodata,"a"
.p2align 6
.amdhsa_kernel standalone__weight_only_int_quip_2__prompt_kernel
  .amdhsa_next_free_vgpr 512
  .amdhsa_next_free_sgpr 96
  .amdhsa_accum_offset 256
  .amdhsa_group_segment_fixed_size 0
  .amdhsa_float_denorm_mode_32 3
  .amdhsa_kernarg_size 56
  .amdhsa_user_sgpr_count 2
  .amdhsa_user_sgpr_kernarg_segment_ptr 1
  .amdhsa_system_sgpr_workgroup_id_x 1
.end_amdhsa_kernel
```
